```python
import torch

def _softmax(x, axis=-1):
    return torch.softmax(x, dim=axis)

def _gelu(x):
    return torch.nn.functional.gelu(x, approximate='tanh')

def _silu(x):
    return torch.nn.functional.silu(x)

def _sigmoid(x):
    return torch.sigmoid(x)

def _layernorm(x, axis=-1, eps=1e-05):
    m = x.mean(dim=axis, keepdim=True)
    v = x.var(dim=axis, keepdim=True, unbiased=False)
    return (x - m) / torch.sqrt(v + eps)

def _scatter_add(tgt, idx, src, axis=0):
    return tgt.clone().index_add_(axis, idx, src)

def _segment_sum(src, seg, n):
    out = torch.zeros((n,) + src.shape[1:], dtype=src.dtype)
    return out.index_add_(0, seg, src)

def _pad(x, pw):
    flat = tuple((v for pair in reversed(pw) for v in pair))
    return torch.nn.functional.pad(x, flat)
kernel_name = 'sequential_preLN__spectral_gfnet__mixer_gmlp__prompt'

def setup_inputs():

    _w = lambda a: (lambda t: t.to(torch.bfloat16) if t.is_floating_point() else t)(torch.as_tensor(a))

    def _A_setup():
        B, S, D = (1, 2048, 1024)
        Df = D // 2 + 1
        return {'x': _w((lambda *s: torch.randn(*s, dtype=torch.bfloat16) * 0.05)(B, S, D)), 'w_r': _w((lambda *s: torch.randn(*s, dtype=torch.bfloat16) * 0.4)(S, Df) * 0.02), 'w_i': _w((lambda *s: torch.randn(*s, dtype=torch.bfloat16) * 0.4)(S, Df) * 0.02)}
    _A_in = _A_setup()

    def _B_setup():
        B, S, D, F = (1, 2048, 1024, 3584)
        Fh = F // 2
        return {'x': _w((lambda *s: torch.randn(*s, dtype=torch.bfloat16) * 0.05)(B, S, D)), 'w_in': _w((lambda *s: torch.randn(*s, dtype=torch.bfloat16) * 0.4)(D, 2 * Fh)), 'w_sp': _w(0.01 * (lambda *s: torch.randn(*s, dtype=torch.bfloat16) * 0.4)(S, S)), 'b_sp': _w(1.0 + 0.01 * (lambda *s: torch.randn(*s, dtype=torch.bfloat16) * 0.05)(S)), 'w_out': _w((lambda *s: torch.randn(*s, dtype=torch.bfloat16) * 0.05)(Fh, D))}
    _B_in = _B_setup()
    return {'A_x': _A_in['x'], 'A_w_r': _A_in['w_r'], 'A_w_i': _A_in['w_i'], 'B_x': _B_in['x'], 'B_w_in': _B_in['w_in'], 'B_w_sp': _B_in['w_sp'], 'B_b_sp': _B_in['b_sp'], 'B_w_out': _B_in['w_out']}

def reference(A_x, A_w_r, A_w_i, B_x, B_w_in, B_w_sp, B_b_sp, B_w_out):

    def _A_ref(x, w_r, w_i):
        B, S, D = x.shape
        X = (lambda x, axes=(-2, -1): torch.fft.rfft2(x.float(), dim=axes))(x, axes=(-2, -1))
        W = w_r + 1j * w_i
        X = X * W
        y = (lambda x, s, axes=(-2, -1): torch.fft.irfft2(x, s=s, dim=axes).to(torch.bfloat16))(X, (S, D), axes=(-2, -1))
        return y

    def _B_ref(x, w_in, w_sp, b_sp, w_out):
        B, S, D = x.shape
        F = w_in.shape[-1]
        Fh = F // 2
        z = _gelu(torch.einsum('bsd,df->bsf', x, w_in))
        z1 = z[..., :Fh].clone()
        z2 = _layernorm(z[..., Fh:], axis=-1)
        g = torch.einsum('ts,bsf->btf', w_sp, z2) + b_sp[None, :, None]
        return torch.einsum('bsf,fd->bsd', z1 * g, w_out)
    x = A_x
    h = x + _A_ref(_layernorm(x, axis=-1), A_w_r, A_w_i)
    h2 = h + _B_ref(_layernorm(h, axis=-1), B_w_in, B_w_sp, B_b_sp, B_w_out)
    return h2
```

```asm
; @launch grid=(256,1,1) block=(512,1,1) lds=163840
.amdgcn_target "amdgcn-amd-amdhsa--gfx950"
.text
  .globl sequential_preLN__spectral_gfnet__mixer_gmlp__prompt_kernel
.p2align 8
.type sequential_preLN__spectral_gfnet__mixer_gmlp__prompt_kernel,@function
sequential_preLN__spectral_gfnet__mixer_gmlp__prompt_kernel:
  s_load_dwordx4 s[80:83], s[0:1], 0
  s_load_dwordx2 s[84:85], s[0:1], 16
  s_load_dwordx8 s[88:95], s[0:1], 32
  s_load_dwordx4 s[96:99], s[0:1], 64
  s_load_dwordx2 s[30:31], s[0:1], 80
  s_cmp_ge_u32 s2, 256
  s_cbranch_scc1 L_done
  v_mov_b32 v1, v0
  v_lshrrev_b32 v2, 6, v0
  v_and_b32 v0, 63, v0
  s_nop 0
  v_readfirstlane_b32 s16, v2
  s_getpc_b64 s[52:53]
L_pc:
  s_lshr_b32 s3, s2, 3
  s_lshl_b32 s3, s3, 3
  s_add_u32 s3, s3, s16
  s_mov_b32 s54, (L_done - L_pc) / 1024
  s_cmp_ge_u32 s3, s54
  s_cbranch_scc1 cpf_1
  s_lshl_b32 s3, s3, 10
  v_lshl_add_u32 v2, v0, 4, s3
  global_load_dwordx4 v[228:231], v2, s[52:53]
cpf_1:
  s_waitcnt lgkmcnt(0)
  s_and_b32 s17, s2, 7
  s_lshl_b32 s17, s17, 1
  s_bfe_u32 s3, s2, 0x10003
  s_or_b32 s17, s17, s3
  s_and_b32 s3, s2, 0xf0
  s_or_b32 s17, s17, s3
  s_mov_b32 s4, s80
  s_mov_b32 s5, s81
  s_mov_b32 s6, 4194304
  s_mov_b32 s7, 0x20000
  s_mov_b32 s8, s82
  s_mov_b32 s9, s83
  s_mov_b32 s10, 2101248
  s_mov_b32 s11, 0x20000
  s_mov_b32 s12, s84
  s_mov_b32 s13, s85
  s_mov_b32 s14, 2101248
  s_mov_b32 s15, 0x20000
  s_add_u32 s36, s30, 71303168
  s_addc_u32 s37, s31, 0
  s_mov_b32 s38, 196608
  s_mov_b32 s39, 0x20000
  s_lshr_b32 s22, s2, 4
  s_lshl_b32 s22, s22, 15
  s_and_b32 s23, s2, 15
  s_lshl_b32 s23, s23, 8
  s_add_u32 s22, s22, s23
  v_mov_b32 v21, 0
  v_lshlrev_b32 v3, 12, v0
  s_cmp_lg_u32 s16, 0
  s_cbranch_scc1 p1clr_2
  s_mov_b64 exec, 0xff
  buffer_store_dword v21, v3, s[36:39], s22 offen sc1
  s_mov_b64 exec, -1
p1clr_2:
  v_lshlrev_b32 v2, 4, v0
  s_lshl_b32 s18, s16, 8
  s_add_u32 s18, s18, s17
  s_lshl_b32 s18, s18, 11
  buffer_load_dwordx4 v[4:7], v2, s[4:7], s18 offen
  buffer_load_dwordx4 v[8:11], v2, s[4:7], s18 offen offset:1024
  s_add_u32 s36, s30, 67108864
  s_addc_u32 s37, s31, 0
  s_mov_b32 s38, 524288
  s_mov_b32 s39, 0x20000
  s_lshl_b32 s22, s2, 11
  s_lshl_b32 s23, s16, 10
  s_add_u32 s22, s22, s23
  s_cmp_lt_u32 s16, 2
  s_cselect_b32 s22, s22, 0x100000
  v_mov_b32 v20, -1
  v_mov_b32 v21, -1
  v_mov_b32 v22, -1
  v_mov_b32 v23, -1
  buffer_store_dwordx4 v[20:23], v2, s[36:39], s22 offen sc1
  v_lshlrev_b32 v108, 4, v0
  v_add_u32 v108, 98304, v108
  v_and_b32 v94, 31, v0
  v_cvt_f32_u32 v94, v94
  v_lshrrev_b32 v95, 5, v0
  v_cvt_f32_u32 v95, v95
  v_and_b32 v109, 15, v0
  v_cvt_f32_u32 v109, v109
  v_lshrrev_b32 v110, 4, v0
  v_cvt_f32_u32 v110, v110
  s_cmp_eq_u32 s16, 0
  s_cbranch_scc1 tblw_4
  s_cmp_eq_u32 s16, 1
  s_cbranch_scc1 tblw_5
  s_cmp_eq_u32 s16, 2
  s_cbranch_scc1 tblw_6
  s_cmp_eq_u32 s16, 3
  s_cbranch_scc1 tblw_7
  s_cmp_eq_u32 s16, 4
  s_cbranch_scc1 tblw_8
  s_cmp_eq_u32 s16, 5
  s_cbranch_scc1 tblw_9
  s_cmp_eq_u32 s16, 6
  s_cbranch_scc1 tblw_10
  s_branch tblw_11
tblw_4:
  v_mul_f32 v92, 0x3d000000, v94
  v_mul_f32 v93, 0x41000000, v95
  v_mul_f32 v93, v93, v92
  v_mov_b32 v96, v93
  v_fmamk_f32 v97, v92, 0x3f800000, v93
  v_fmamk_f32 v98, v92, 0x40000000, v93
  v_fmamk_f32 v99, v92, 0x40400000, v93
  v_fmamk_f32 v100, v92, 0x40800000, v93
  v_fmamk_f32 v101, v92, 0x40a00000, v93
  v_fmamk_f32 v102, v92, 0x40c00000, v93
  v_fmamk_f32 v103, v92, 0x40e00000, v93
  v_cos_f32 v96, v96
  v_cos_f32 v97, v97
  v_cos_f32 v98, v98
  v_cos_f32 v99, v99
  v_cos_f32 v100, v100
  v_cos_f32 v101, v101
  v_cos_f32 v102, v102
  v_cos_f32 v103, v103
  s_nop 0
  v_cvt_pk_bf16_f32 v112, v96, v97
  v_cvt_pk_bf16_f32 v113, v98, v99
  v_cvt_pk_bf16_f32 v114, v100, v101
  v_cvt_pk_bf16_f32 v115, v102, v103
  ds_write_b128 v108, v[112:115] offset:0
  v_fmamk_f32 v96, v92, 0x41800000, v93
  v_fmamk_f32 v97, v92, 0x41880000, v93
  v_fmamk_f32 v98, v92, 0x41900000, v93
  v_fmamk_f32 v99, v92, 0x41980000, v93
  v_fmamk_f32 v100, v92, 0x41a00000, v93
  v_fmamk_f32 v101, v92, 0x41a80000, v93
  v_fmamk_f32 v102, v92, 0x41b00000, v93
  v_fmamk_f32 v103, v92, 0x41b80000, v93
  v_cos_f32 v96, v96
  v_cos_f32 v97, v97
  v_cos_f32 v98, v98
  v_cos_f32 v99, v99
  v_cos_f32 v100, v100
  v_cos_f32 v101, v101
  v_cos_f32 v102, v102
  v_cos_f32 v103, v103
  s_nop 0
  v_cvt_pk_bf16_f32 v116, v96, v97
  v_cvt_pk_bf16_f32 v117, v98, v99
  v_cvt_pk_bf16_f32 v118, v100, v101
  v_cvt_pk_bf16_f32 v119, v102, v103
  ds_write_b128 v108, v[116:119] offset:1024
  v_mov_b32 v96, v93
  v_fmamk_f32 v97, v92, 0x3f800000, v93
  v_fmamk_f32 v98, v92, 0x40000000, v93
  v_fmamk_f32 v99, v92, 0x40400000, v93
  v_fmamk_f32 v100, v92, 0x40800000, v93
  v_fmamk_f32 v101, v92, 0x40a00000, v93
  v_fmamk_f32 v102, v92, 0x40c00000, v93
  v_fmamk_f32 v103, v92, 0x40e00000, v93
  v_add_f32 v96, 0x3e800000, v96
  v_add_f32 v97, 0x3e800000, v97
  v_add_f32 v98, 0x3e800000, v98
  v_add_f32 v99, 0x3e800000, v99
  v_add_f32 v100, 0x3e800000, v100
  v_add_f32 v101, 0x3e800000, v101
  v_add_f32 v102, 0x3e800000, v102
  v_add_f32 v103, 0x3e800000, v103
  v_cos_f32 v96, v96
  v_cos_f32 v97, v97
  v_cos_f32 v98, v98
  v_cos_f32 v99, v99
  v_cos_f32 v100, v100
  v_cos_f32 v101, v101
  v_cos_f32 v102, v102
  v_cos_f32 v103, v103
  s_nop 0
  v_cvt_pk_bf16_f32 v112, v96, v97
  v_cvt_pk_bf16_f32 v113, v98, v99
  v_cvt_pk_bf16_f32 v114, v100, v101
  v_cvt_pk_bf16_f32 v115, v102, v103
  ds_write_b128 v108, v[112:115] offset:2048
  s_branch tblend_3
tblw_5:
  v_mul_f32 v92, 0x3d000000, v94
  v_mul_f32 v93, 0x41000000, v95
  v_mul_f32 v93, v93, v92
  v_fmamk_f32 v96, v92, 0x41800000, v93
  v_fmamk_f32 v97, v92, 0x41880000, v93
  v_fmamk_f32 v98, v92, 0x41900000, v93
  v_fmamk_f32 v99, v92, 0x41980000, v93
  v_fmamk_f32 v100, v92, 0x41a00000, v93
  v_fmamk_f32 v101, v92, 0x41a80000, v93
  v_fmamk_f32 v102, v92, 0x41b00000, v93
  v_fmamk_f32 v103, v92, 0x41b80000, v93
  v_add_f32 v96, 0x3e800000, v96
  v_add_f32 v97, 0x3e800000, v97
  v_add_f32 v98, 0x3e800000, v98
  v_add_f32 v99, 0x3e800000, v99
  v_add_f32 v100, 0x3e800000, v100
  v_add_f32 v101, 0x3e800000, v101
  v_add_f32 v102, 0x3e800000, v102
  v_add_f32 v103, 0x3e800000, v103
  v_cos_f32 v96, v96
  v_cos_f32 v97, v97
  v_cos_f32 v98, v98
  v_cos_f32 v99, v99
  v_cos_f32 v100, v100
  v_cos_f32 v101, v101
  v_cos_f32 v102, v102
  v_cos_f32 v103, v103
  s_nop 0
  v_cvt_pk_bf16_f32 v116, v96, v97
  v_cvt_pk_bf16_f32 v117, v98, v99
  v_cvt_pk_bf16_f32 v118, v100, v101
  v_cvt_pk_bf16_f32 v119, v102, v103
  ds_write_b128 v108, v[116:119] offset:3072
  v_bfe_u32 v92, v0, 1, 4
  v_cvt_f32_u32 v92, v92
  v_mul_f32 v92, 0x3d000000, v92
  v_and_b32 v96, 1, v0
  v_cvt_f32_u32 v96, v96
  v_mul_f32 v96, 0x3e800000, v96
  v_mul_f32 v93, 4.0, v95
  v_fma_f32 v93, v93, v92, v96
  v_mov_b32 v96, v93
  v_fmamk_f32 v97, v92, 0x3f800000, v93
  v_fmamk_f32 v98, v92, 0x40000000, v93
  v_fmamk_f32 v99, v92, 0x40400000, v93
  v_fmamk_f32 v100, v92, 0x41000000, v93
  v_fmamk_f32 v101, v92, 0x41100000, v93
  v_fmamk_f32 v102, v92, 0x41200000, v93
  v_fmamk_f32 v103, v92, 0x41300000, v93
  v_cos_f32 v96, v96
  v_cos_f32 v97, v97
  v_cos_f32 v98, v98
  v_cos_f32 v99, v99
  v_cos_f32 v100, v100
  v_cos_f32 v101, v101
  v_cos_f32 v102, v102
  v_cos_f32 v103, v103
  s_nop 0
  v_cvt_pk_bf16_f32 v112, v96, v97
  v_cvt_pk_bf16_f32 v113, v98, v99
  v_cvt_pk_bf16_f32 v114, v100, v101
  v_cvt_pk_bf16_f32 v115, v102, v103
  ds_write_b128 v108, v[112:115] offset:12288
  v_fmamk_f32 v96, v92, 0x41800000, v93
  v_fmamk_f32 v97, v92, 0x41880000, v93
  v_fmamk_f32 v98, v92, 0x41900000, v93
  v_fmamk_f32 v99, v92, 0x41980000, v93
  v_fmamk_f32 v100, v92, 0x41c00000, v93
  v_fmamk_f32 v101, v92, 0x41c80000, v93
  v_fmamk_f32 v102, v92, 0x41d00000, v93
  v_fmamk_f32 v103, v92, 0x41d80000, v93
  v_cos_f32 v96, v96
  v_cos_f32 v97, v97
  v_cos_f32 v98, v98
  v_cos_f32 v99, v99
  v_cos_f32 v100, v100
  v_cos_f32 v101, v101
  v_cos_f32 v102, v102
  v_cos_f32 v103, v103
  s_nop 0
  v_cvt_pk_bf16_f32 v116, v96, v97
  v_cvt_pk_bf16_f32 v117, v98, v99
  v_cvt_pk_bf16_f32 v118, v100, v101
  v_cvt_pk_bf16_f32 v119, v102, v103
  ds_write_b128 v108, v[116:119] offset:13312
  s_branch tblend_3
tblw_6:
  v_bfe_u32 v92, v0, 1, 4
  v_cvt_f32_u32 v92, v92
  v_mul_f32 v92, 0x3d000000, v92
  v_and_b32 v96, 1, v0
  v_cvt_f32_u32 v96, v96
  v_mul_f32 v96, 0x3e800000, v96
  v_mul_f32 v93, 4.0, v95
  v_fma_f32 v93, v93, v92, v96
  v_mov_b32 v96, v93
  v_fmamk_f32 v97, v92, 0x3f800000, v93
  v_fmamk_f32 v98, v92, 0x40000000, v93
  v_fmamk_f32 v99, v92, 0x40400000, v93
  v_fmamk_f32 v100, v92, 0x41000000, v93
  v_fmamk_f32 v101, v92, 0x41100000, v93
  v_fmamk_f32 v102, v92, 0x41200000, v93
  v_fmamk_f32 v103, v92, 0x41300000, v93
  v_add_f32 v96, 0xbe800000, v96
  v_add_f32 v97, 0xbe800000, v97
  v_add_f32 v98, 0xbe800000, v98
  v_add_f32 v99, 0xbe800000, v99
  v_add_f32 v100, 0xbe800000, v100
  v_add_f32 v101, 0xbe800000, v101
  v_add_f32 v102, 0xbe800000, v102
  v_add_f32 v103, 0xbe800000, v103
  v_cos_f32 v96, v96
  v_cos_f32 v97, v97
  v_cos_f32 v98, v98
  v_cos_f32 v99, v99
  v_cos_f32 v100, v100
  v_cos_f32 v101, v101
  v_cos_f32 v102, v102
  v_cos_f32 v103, v103
  s_nop 0
  v_cvt_pk_bf16_f32 v112, v96, v97
  v_cvt_pk_bf16_f32 v113, v98, v99
  v_cvt_pk_bf16_f32 v114, v100, v101
  v_cvt_pk_bf16_f32 v115, v102, v103
  ds_write_b128 v108, v[112:115] offset:14336
  v_fmamk_f32 v96, v92, 0x41800000, v93
  v_fmamk_f32 v97, v92, 0x41880000, v93
  v_fmamk_f32 v98, v92, 0x41900000, v93
  v_fmamk_f32 v99, v92, 0x41980000, v93
  v_fmamk_f32 v100, v92, 0x41c00000, v93
  v_fmamk_f32 v101, v92, 0x41c80000, v93
  v_fmamk_f32 v102, v92, 0x41d00000, v93
  v_fmamk_f32 v103, v92, 0x41d80000, v93
  v_add_f32 v96, 0xbe800000, v96
  v_add_f32 v97, 0xbe800000, v97
  v_add_f32 v98, 0xbe800000, v98
  v_add_f32 v99, 0xbe800000, v99
  v_add_f32 v100, 0xbe800000, v100
  v_add_f32 v101, 0xbe800000, v101
  v_add_f32 v102, 0xbe800000, v102
  v_add_f32 v103, 0xbe800000, v103
  v_cos_f32 v96, v96
  v_cos_f32 v97, v97
  v_cos_f32 v98, v98
  v_cos_f32 v99, v99
  v_cos_f32 v100, v100
  v_cos_f32 v101, v101
  v_cos_f32 v102, v102
  v_cos_f32 v103, v103
  s_nop 0
  v_cvt_pk_bf16_f32 v116, v96, v97
  v_cvt_pk_bf16_f32 v117, v98, v99
  v_cvt_pk_bf16_f32 v118, v100, v101
  v_cvt_pk_bf16_f32 v119, v102, v103
  ds_write_b128 v108, v[116:119] offset:15360
  v_bfe_u32 v96, v0, 2, 1
  v_lshlrev_b32 v96, 2, v96
  v_bfe_u32 v97, v0, 3, 1
  v_lshl_add_u32 v96, v97, 1, v96
  v_bfe_u32 v97, v0, 1, 1
  v_add_u32 v96, v96, v97
  v_cvt_f32_u32 v96, v96
  v_mul_f32 v92, 0x3e000000, v96
  v_cvt_f32_u32 v97, s17
  v_mul_f32 v97, 0x3a000000, v97
  v_mul_f32 v93, v96, v97
  v_and_b32 v97, 1, v0
  v_cvt_f32_u32 v97, v97
  v_fmamk_f32 v93, v97, 0x3e800000, v93
  v_mul_f32 v97, 4.0, v95
  v_fma_f32 v93, v97, v92, v93
  v_mov_b32 v96, v93
  v_mov_b32 v97, v93
  v_fmamk_f32 v98, v92, 0x3f800000, v93
  v_fmamk_f32 v99, v92, 0x3f800000, v93
  v_fmamk_f32 v100, v92, 0x40000000, v93
  v_fmamk_f32 v101, v92, 0x40000000, v93
  v_fmamk_f32 v102, v92, 0x40400000, v93
  v_fmamk_f32 v103, v92, 0x40400000, v93
  v_add_f32 v97, 0xbe800000, v97
  v_add_f32 v99, 0xbe800000, v99
  v_add_f32 v101, 0xbe800000, v101
  v_add_f32 v103, 0xbe800000, v103
  v_cos_f32 v96, v96
  v_cos_f32 v97, v97
  v_cos_f32 v98, v98
  v_cos_f32 v99, v99
  v_cos_f32 v100, v100
  v_cos_f32 v101, v101
  v_cos_f32 v102, v102
  v_cos_f32 v103, v103
  s_nop 0
  v_cvt_pk_bf16_f32 v112, v96, v97
  v_cvt_pk_bf16_f32 v113, v98, v99
  v_cvt_pk_bf16_f32 v114, v100, v101
  v_cvt_pk_bf16_f32 v115, v102, v103
  ds_write_b128 v108, v[112:115] offset:16384
  s_branch tblend_3
tblw_7:
  v_mul_f32 v92, 0x3a800000, v94
  v_mul_f32 v93, 4.0, v95
  v_mul_f32 v93, v93, v92
  v_mov_b32 v96, v93
  v_fmamk_f32 v97, v92, 0x3f800000, v93
  v_fmamk_f32 v98, v92, 0x40000000, v93
  v_fmamk_f32 v99, v92, 0x40400000, v93
  v_cos_f32 v116, v96
  v_cos_f32 v117, v97
  v_cos_f32 v118, v98
  v_cos_f32 v119, v99
  v_sin_f32 v100, v96
  v_sin_f32 v101, v97
  v_sin_f32 v102, v98
  v_sin_f32 v103, v99
  s_nop 0
  ds_write_b128 v108, v[116:119] offset:4096
  ds_write_b128 v108, v[100:103] offset:8192
  v_fmamk_f32 v96, v92, 0x41000000, v93
  v_fmamk_f32 v97, v92, 0x41100000, v93
  v_fmamk_f32 v98, v92, 0x41200000, v93
  v_fmamk_f32 v99, v92, 0x41300000, v93
  v_cos_f32 v112, v96
  v_cos_f32 v113, v97
  v_cos_f32 v114, v98
  v_cos_f32 v115, v99
  v_sin_f32 v100, v96
  v_sin_f32 v101, v97
  v_sin_f32 v102, v98
  v_sin_f32 v103, v99
  s_nop 0
  ds_write_b128 v108, v[112:115] offset:5120
  ds_write_b128 v108, v[100:103] offset:9216
  v_fmamk_f32 v96, v92, 0x41800000, v93
  v_fmamk_f32 v97, v92, 0x41880000, v93
  v_fmamk_f32 v98, v92, 0x41900000, v93
  v_fmamk_f32 v99, v92, 0x41980000, v93
  v_cos_f32 v116, v96
  v_cos_f32 v117, v97
  v_cos_f32 v118, v98
  v_cos_f32 v119, v99
  v_sin_f32 v100, v96
  v_sin_f32 v101, v97
  v_sin_f32 v102, v98
  v_sin_f32 v103, v99
  s_nop 0
  ds_write_b128 v108, v[116:119] offset:6144
  ds_write_b128 v108, v[100:103] offset:10240
  v_fmamk_f32 v96, v92, 0x41c00000, v93
  v_fmamk_f32 v97, v92, 0x41c80000, v93
  v_fmamk_f32 v98, v92, 0x41d00000, v93
  v_fmamk_f32 v99, v92, 0x41d80000, v93
  v_cos_f32 v112, v96
  v_cos_f32 v113, v97
  v_cos_f32 v114, v98
  v_cos_f32 v115, v99
  v_sin_f32 v100, v96
  v_sin_f32 v101, v97
  v_sin_f32 v102, v98
  v_sin_f32 v103, v99
  s_nop 0
  ds_write_b128 v108, v[112:115] offset:7168
  ds_write_b128 v108, v[100:103] offset:11264
  v_mul_f32 v92, 0x3b800000, v109
  v_mul_f32 v93, 4.0, v110
  v_mul_f32 v93, v93, v92
  v_mov_b32 v96, v93
  v_fmamk_f32 v97, v92, 0x3f800000, v93
  v_fmamk_f32 v98, v92, 0x40000000, v93
  v_fmamk_f32 v99, v92, 0x40400000, v93
  v_cos_f32 v116, v96
  v_cos_f32 v117, v97
  v_cos_f32 v118, v98
  v_cos_f32 v119, v99
  v_sin_f32 v100, v96
  v_sin_f32 v101, v97
  v_sin_f32 v102, v98
  v_sin_f32 v103, v99
  s_nop 0
  ds_write_b128 v108, v[116:119] offset:21504
  ds_write_b128 v108, v[100:103] offset:22528
  v_bfe_u32 v96, v0, 2, 1
  v_lshlrev_b32 v96, 2, v96
  v_bfe_u32 v97, v0, 3, 1
  v_lshl_add_u32 v96, v97, 1, v96
  v_bfe_u32 v97, v0, 1, 1
  v_add_u32 v96, v96, v97
  v_cvt_f32_u32 v96, v96
  v_cvt_f32_u32 v97, s17
  v_mul_f32 v97, 0x3a000000, v97
  v_fmamk_f32 v92, v96, 0x3e000000, v97
  v_and_b32 v97, 1, v0
  v_cvt_f32_u32 v97, v97
  v_mul_f32 v97, 0xbe800000, v97
  v_mul_f32 v93, 4.0, v95
  v_fma_f32 v93, v93, v92, v97
  v_mov_b32 v96, v93
  v_mov_b32 v97, v93
  v_fmamk_f32 v98, v92, 0x3f800000, v93
  v_fmamk_f32 v99, v92, 0x3f800000, v93
  v_fmamk_f32 v100, v92, 0x40000000, v93
  v_fmamk_f32 v101, v92, 0x40000000, v93
  v_fmamk_f32 v102, v92, 0x40400000, v93
  v_fmamk_f32 v103, v92, 0x40400000, v93
  v_add_f32 v97, 0x3e800000, v97
  v_add_f32 v99, 0x3e800000, v99
  v_add_f32 v101, 0x3e800000, v101
  v_add_f32 v103, 0x3e800000, v103
  v_cos_f32 v96, v96
  v_cos_f32 v97, v97
  v_cos_f32 v98, v98
  v_cos_f32 v99, v99
  v_cos_f32 v100, v100
  v_cos_f32 v101, v101
  v_cos_f32 v102, v102
  v_cos_f32 v103, v103
  s_nop 0
  v_cvt_pk_bf16_f32 v112, v96, v97
  v_cvt_pk_bf16_f32 v113, v98, v99
  v_cvt_pk_bf16_f32 v114, v100, v101
  v_cvt_pk_bf16_f32 v115, v102, v103
  ds_write_b128 v108, v[112:115] offset:27648
  s_branch tblend_3
tblw_8:
  v_mul_f32 v92, 0x3d800000, v109
  v_mul_f32 v93, 4.0, v110
  v_mul_f32 v93, v93, v92
  v_mov_b32 v96, v93
  v_mov_b32 v97, v93
  v_fmamk_f32 v98, v92, 0x3f800000, v93
  v_fmamk_f32 v99, v92, 0x3f800000, v93
  v_fmamk_f32 v100, v92, 0x40000000, v93
  v_fmamk_f32 v101, v92, 0x40000000, v93
  v_fmamk_f32 v102, v92, 0x40400000, v93
  v_fmamk_f32 v103, v92, 0x40400000, v93
  v_add_f32 v97, 0xbe800000, v97
  v_add_f32 v99, 0xbe800000, v99
  v_add_f32 v101, 0xbe800000, v101
  v_add_f32 v103, 0xbe800000, v103
  v_cos_f32 v96, v96
  v_cos_f32 v97, v97
  v_cos_f32 v98, v98
  v_cos_f32 v99, v99
  v_cos_f32 v100, v100
  v_cos_f32 v101, v101
  v_cos_f32 v102, v102
  v_cos_f32 v103, v103
  s_nop 0
  v_cvt_pk_bf16_f32 v116, v96, v97
  v_cvt_pk_bf16_f32 v117, v98, v99
  v_cvt_pk_bf16_f32 v118, v100, v101
  v_cvt_pk_bf16_f32 v119, v102, v103
  ds_write_b128 v108, v[116:119] offset:17408
  v_mov_b32 v96, v93
  v_mov_b32 v97, v93
  v_fmamk_f32 v98, v92, 0x3f800000, v93
  v_fmamk_f32 v99, v92, 0x3f800000, v93
  v_fmamk_f32 v100, v92, 0x40000000, v93
  v_fmamk_f32 v101, v92, 0x40000000, v93
  v_fmamk_f32 v102, v92, 0x40400000, v93
  v_fmamk_f32 v103, v92, 0x40400000, v93
  v_add_f32 v96, 0x3e800000, v96
  v_add_f32 v98, 0x3e800000, v98
  v_add_f32 v100, 0x3e800000, v100
  v_add_f32 v102, 0x3e800000, v102
  v_cos_f32 v96, v96
  v_cos_f32 v97, v97
  v_cos_f32 v98, v98
  v_cos_f32 v99, v99
  v_cos_f32 v100, v100
  v_cos_f32 v101, v101
  v_cos_f32 v102, v102
  v_cos_f32 v103, v103
  s_nop 0
  v_cvt_pk_bf16_f32 v112, v96, v97
  v_cvt_pk_bf16_f32 v113, v98, v99
  v_cvt_pk_bf16_f32 v114, v100, v101
  v_cvt_pk_bf16_f32 v115, v102, v103
  ds_write_b128 v108, v[112:115] offset:18432
  v_mul_f32 v92, 0x3d800000, v109
  v_mul_f32 v93, 2.0, v110
  v_mul_f32 v93, v93, v92
  v_mov_b32 v96, v93
  v_mov_b32 v97, v93
  v_fmamk_f32 v98, v92, 0x3f800000, v93
  v_fmamk_f32 v99, v92, 0x3f800000, v93
  v_fmamk_f32 v100, v92, 0x41000000, v93
  v_fmamk_f32 v101, v92, 0x41000000, v93
  v_fmamk_f32 v102, v92, 0x41100000, v93
  v_fmamk_f32 v103, v92, 0x41100000, v93
  v_add_f32 v97, 0x3e800000, v97
  v_add_f32 v99, 0x3e800000, v99
  v_add_f32 v101, 0x3e800000, v101
  v_add_f32 v103, 0x3e800000, v103
  v_cos_f32 v96, v96
  v_cos_f32 v97, v97
  v_cos_f32 v98, v98
  v_cos_f32 v99, v99
  v_cos_f32 v100, v100
  v_cos_f32 v101, v101
  v_cos_f32 v102, v102
  v_cos_f32 v103, v103
  s_nop 0
  v_cvt_pk_bf16_f32 v116, v96, v97
  v_cvt_pk_bf16_f32 v117, v98, v99
  v_cvt_pk_bf16_f32 v118, v100, v101
  v_cvt_pk_bf16_f32 v119, v102, v103
  ds_write_b128 v108, v[116:119] offset:19456
  v_mov_b32 v96, v93
  v_mov_b32 v97, v93
  v_fmamk_f32 v98, v92, 0x3f800000, v93
  v_fmamk_f32 v99, v92, 0x3f800000, v93
  v_fmamk_f32 v100, v92, 0x41000000, v93
  v_fmamk_f32 v101, v92, 0x41000000, v93
  v_fmamk_f32 v102, v92, 0x41100000, v93
  v_fmamk_f32 v103, v92, 0x41100000, v93
  v_add_f32 v96, 0xbe800000, v96
  v_add_f32 v98, 0xbe800000, v98
  v_add_f32 v100, 0xbe800000, v100
  v_add_f32 v102, 0xbe800000, v102
  v_cos_f32 v96, v96
  v_cos_f32 v97, v97
  v_cos_f32 v98, v98
  v_cos_f32 v99, v99
  v_cos_f32 v100, v100
  v_cos_f32 v101, v101
  v_cos_f32 v102, v102
  v_cos_f32 v103, v103
  s_nop 0
  v_cvt_pk_bf16_f32 v112, v96, v97
  v_cvt_pk_bf16_f32 v113, v98, v99
  v_cvt_pk_bf16_f32 v114, v100, v101
  v_cvt_pk_bf16_f32 v115, v102, v103
  ds_write_b128 v108, v[112:115] offset:20480
  s_branch tblend_3
tblw_9:
  v_and_b32 v111, 1, v0
  v_cvt_f32_u32 v111, v111
  v_mul_f32 v111, 0x3e800000, v111
  v_bfe_u32 v92, v0, 1, 3
  v_add_u32 v92, 0, v92
  v_cvt_f32_u32 v92, v92
  v_mul_f32 v92, 0x3d800000, v92
  v_mul_f32 v104, 4.0, v110
  v_mul_f32 v104, v104, v92
  v_add_f32 v93, v104, v111
  v_mov_b32 v96, v93
  v_mov_b32 v97, v93
  v_fmamk_f32 v98, v92, 0x3f800000, v93
  v_fmamk_f32 v99, v92, 0x3f800000, v93
  v_fmamk_f32 v100, v92, 0x40000000, v93
  v_fmamk_f32 v101, v92, 0x40000000, v93
  v_fmamk_f32 v102, v92, 0x40400000, v93
  v_fmamk_f32 v103, v92, 0x40400000, v93
  v_add_f32 v97, 0xbe800000, v97
  v_add_f32 v99, 0xbe800000, v99
  v_add_f32 v101, 0xbe800000, v101
  v_add_f32 v103, 0xbe800000, v103
  v_cos_f32 v96, v96
  v_cos_f32 v97, v97
  v_cos_f32 v98, v98
  v_cos_f32 v99, v99
  v_cos_f32 v100, v100
  v_cos_f32 v101, v101
  v_cos_f32 v102, v102
  v_cos_f32 v103, v103
  s_nop 0
  v_cvt_pk_bf16_f32 v116, v96, v97
  v_cvt_pk_bf16_f32 v117, v98, v99
  v_cvt_pk_bf16_f32 v118, v100, v101
  v_cvt_pk_bf16_f32 v119, v102, v103
  ds_write_b128 v108, v[116:119] offset:23552
  v_sub_f32 v93, v104, v111
  v_mov_b32 v96, v93
  v_mov_b32 v97, v93
  v_fmamk_f32 v98, v92, 0x3f800000, v93
  v_fmamk_f32 v99, v92, 0x3f800000, v93
  v_fmamk_f32 v100, v92, 0x40000000, v93
  v_fmamk_f32 v101, v92, 0x40000000, v93
  v_fmamk_f32 v102, v92, 0x40400000, v93
  v_fmamk_f32 v103, v92, 0x40400000, v93
  v_add_f32 v97, 0x3e800000, v97
  v_add_f32 v99, 0x3e800000, v99
  v_add_f32 v101, 0x3e800000, v101
  v_add_f32 v103, 0x3e800000, v103
  v_cos_f32 v96, v96
  v_cos_f32 v97, v97
  v_cos_f32 v98, v98
  v_cos_f32 v99, v99
  v_cos_f32 v100, v100
  v_cos_f32 v101, v101
  v_cos_f32 v102, v102
  v_cos_f32 v103, v103
  s_nop 0
  v_cvt_pk_bf16_f32 v112, v96, v97
  v_cvt_pk_bf16_f32 v113, v98, v99
  v_cvt_pk_bf16_f32 v114, v100, v101
  v_cvt_pk_bf16_f32 v115, v102, v103
  ds_write_b128 v108, v[112:115] offset:24576
  v_and_b32 v111, 1, v0
  v_cvt_f32_u32 v111, v111
  v_mul_f32 v111, 0x3e800000, v111
  v_bfe_u32 v92, v0, 1, 3
  v_add_u32 v92, 8, v92
  v_cvt_f32_u32 v92, v92
  v_mul_f32 v92, 0x3d800000, v92
  v_mul_f32 v104, 4.0, v110
  v_mul_f32 v104, v104, v92
  v_add_f32 v93, v104, v111
  v_mov_b32 v96, v93
  v_mov_b32 v97, v93
  v_fmamk_f32 v98, v92, 0x3f800000, v93
  v_fmamk_f32 v99, v92, 0x3f800000, v93
  v_fmamk_f32 v100, v92, 0x40000000, v93
  v_fmamk_f32 v101, v92, 0x40000000, v93
  v_fmamk_f32 v102, v92, 0x40400000, v93
  v_fmamk_f32 v103, v92, 0x40400000, v93
  v_add_f32 v97, 0xbe800000, v97
  v_add_f32 v99, 0xbe800000, v99
  v_add_f32 v101, 0xbe800000, v101
  v_add_f32 v103, 0xbe800000, v103
  v_cos_f32 v96, v96
  v_cos_f32 v97, v97
  v_cos_f32 v98, v98
  v_cos_f32 v99, v99
  v_cos_f32 v100, v100
  v_cos_f32 v101, v101
  v_cos_f32 v102, v102
  v_cos_f32 v103, v103
  s_nop 0
  v_cvt_pk_bf16_f32 v116, v96, v97
  v_cvt_pk_bf16_f32 v117, v98, v99
  v_cvt_pk_bf16_f32 v118, v100, v101
  v_cvt_pk_bf16_f32 v119, v102, v103
  ds_write_b128 v108, v[116:119] offset:25600
  v_sub_f32 v93, v104, v111
  v_mov_b32 v96, v93
  v_mov_b32 v97, v93
  v_fmamk_f32 v98, v92, 0x3f800000, v93
  v_fmamk_f32 v99, v92, 0x3f800000, v93
  v_fmamk_f32 v100, v92, 0x40000000, v93
  v_fmamk_f32 v101, v92, 0x40000000, v93
  v_fmamk_f32 v102, v92, 0x40400000, v93
  v_fmamk_f32 v103, v92, 0x40400000, v93
  v_add_f32 v97, 0x3e800000, v97
  v_add_f32 v99, 0x3e800000, v99
  v_add_f32 v101, 0x3e800000, v101
  v_add_f32 v103, 0x3e800000, v103
  v_cos_f32 v96, v96
  v_cos_f32 v97, v97
  v_cos_f32 v98, v98
  v_cos_f32 v99, v99
  v_cos_f32 v100, v100
  v_cos_f32 v101, v101
  v_cos_f32 v102, v102
  v_cos_f32 v103, v103
  s_nop 0
  v_cvt_pk_bf16_f32 v112, v96, v97
  v_cvt_pk_bf16_f32 v113, v98, v99
  v_cvt_pk_bf16_f32 v114, v100, v101
  v_cvt_pk_bf16_f32 v115, v102, v103
  ds_write_b128 v108, v[112:115] offset:26624
  s_branch tblend_3
tblw_10:
  v_mul_f32 v92, 0x3d000000, v94
  v_mul_f32 v93, 4.0, v95
  v_mul_f32 v93, v93, v92
  v_mov_b32 v96, v93
  v_mov_b32 v97, v93
  v_fmamk_f32 v98, v92, 0x3f800000, v93
  v_fmamk_f32 v99, v92, 0x3f800000, v93
  v_fmamk_f32 v100, v92, 0x40000000, v93
  v_fmamk_f32 v101, v92, 0x40000000, v93
  v_fmamk_f32 v102, v92, 0x40400000, v93
  v_fmamk_f32 v103, v92, 0x40400000, v93
  v_add_f32 v97, 0x3e800000, v97
  v_add_f32 v99, 0x3e800000, v99
  v_add_f32 v101, 0x3e800000, v101
  v_add_f32 v103, 0x3e800000, v103
  v_cos_f32 v96, v96
  v_cos_f32 v97, v97
  v_cos_f32 v98, v98
  v_cos_f32 v99, v99
  v_cos_f32 v100, v100
  v_cos_f32 v101, v101
  v_cos_f32 v102, v102
  v_cos_f32 v103, v103
  s_nop 0
  v_cvt_pk_bf16_f32 v116, v96, v97
  v_cvt_pk_bf16_f32 v117, v98, v99
  v_cvt_pk_bf16_f32 v118, v100, v101
  v_cvt_pk_bf16_f32 v119, v102, v103
  ds_write_b128 v108, v[116:119] offset:28672
  v_fmamk_f32 v96, v92, 0x41000000, v93
  v_fmamk_f32 v97, v92, 0x41000000, v93
  v_fmamk_f32 v98, v92, 0x41100000, v93
  v_fmamk_f32 v99, v92, 0x41100000, v93
  v_fmamk_f32 v100, v92, 0x41200000, v93
  v_fmamk_f32 v101, v92, 0x41200000, v93
  v_fmamk_f32 v102, v92, 0x41300000, v93
  v_fmamk_f32 v103, v92, 0x41300000, v93
  v_add_f32 v97, 0x3e800000, v97
  v_add_f32 v99, 0x3e800000, v99
  v_add_f32 v101, 0x3e800000, v101
  v_add_f32 v103, 0x3e800000, v103
  v_cos_f32 v96, v96
  v_cos_f32 v97, v97
  v_cos_f32 v98, v98
  v_cos_f32 v99, v99
  v_cos_f32 v100, v100
  v_cos_f32 v101, v101
  v_cos_f32 v102, v102
  v_cos_f32 v103, v103
  s_nop 0
  v_cvt_pk_bf16_f32 v112, v96, v97
  v_cvt_pk_bf16_f32 v113, v98, v99
  v_cvt_pk_bf16_f32 v114, v100, v101
  v_cvt_pk_bf16_f32 v115, v102, v103
  ds_write_b128 v108, v[112:115] offset:29696
  v_mov_b32 v96, v93
  v_mov_b32 v97, v93
  v_fmamk_f32 v98, v92, 0x3f800000, v93
  v_fmamk_f32 v99, v92, 0x3f800000, v93
  v_fmamk_f32 v100, v92, 0x40000000, v93
  v_fmamk_f32 v101, v92, 0x40000000, v93
  v_fmamk_f32 v102, v92, 0x40400000, v93
  v_fmamk_f32 v103, v92, 0x40400000, v93
  v_add_f32 v96, 0xbe800000, v96
  v_add_f32 v98, 0xbe800000, v98
  v_add_f32 v100, 0xbe800000, v100
  v_add_f32 v102, 0xbe800000, v102
  v_cos_f32 v96, v96
  v_cos_f32 v97, v97
  v_cos_f32 v98, v98
  v_cos_f32 v99, v99
  v_cos_f32 v100, v100
  v_cos_f32 v101, v101
  v_cos_f32 v102, v102
  v_cos_f32 v103, v103
  s_nop 0
  v_cvt_pk_bf16_f32 v116, v96, v97
  v_cvt_pk_bf16_f32 v117, v98, v99
  v_cvt_pk_bf16_f32 v118, v100, v101
  v_cvt_pk_bf16_f32 v119, v102, v103
  ds_write_b128 v108, v[116:119] offset:30720
  v_fmamk_f32 v96, v92, 0x41000000, v93
  v_fmamk_f32 v97, v92, 0x41000000, v93
  v_fmamk_f32 v98, v92, 0x41100000, v93
  v_fmamk_f32 v99, v92, 0x41100000, v93
  v_fmamk_f32 v100, v92, 0x41200000, v93
  v_fmamk_f32 v101, v92, 0x41200000, v93
  v_fmamk_f32 v102, v92, 0x41300000, v93
  v_fmamk_f32 v103, v92, 0x41300000, v93
  v_add_f32 v96, 0xbe800000, v96
  v_add_f32 v98, 0xbe800000, v98
  v_add_f32 v100, 0xbe800000, v100
  v_add_f32 v102, 0xbe800000, v102
  v_cos_f32 v96, v96
  v_cos_f32 v97, v97
  v_cos_f32 v98, v98
  v_cos_f32 v99, v99
  v_cos_f32 v100, v100
  v_cos_f32 v101, v101
  v_cos_f32 v102, v102
  v_cos_f32 v103, v103
  s_nop 0
  v_cvt_pk_bf16_f32 v112, v96, v97
  v_cvt_pk_bf16_f32 v113, v98, v99
  v_cvt_pk_bf16_f32 v114, v100, v101
  v_cvt_pk_bf16_f32 v115, v102, v103
  ds_write_b128 v108, v[112:115] offset:31744
  s_branch tblend_3
tblw_11:
  v_mul_f32 v92, 0x3d000000, v94
  v_mul_f32 v93, 4.0, v95
  v_mul_f32 v93, v93, v92
  v_mov_b32 v96, v93
  v_fmamk_f32 v97, v92, 0x3f800000, v93
  v_fmamk_f32 v98, v92, 0x40000000, v93
  v_fmamk_f32 v99, v92, 0x40400000, v93
  v_fmamk_f32 v100, v92, 0x41000000, v93
  v_fmamk_f32 v101, v92, 0x41100000, v93
  v_fmamk_f32 v102, v92, 0x41200000, v93
  v_fmamk_f32 v103, v92, 0x41300000, v93
  v_cos_f32 v96, v96
  v_cos_f32 v97, v97
  v_cos_f32 v98, v98
  v_cos_f32 v99, v99
  v_cos_f32 v100, v100
  v_cos_f32 v101, v101
  v_cos_f32 v102, v102
  v_cos_f32 v103, v103
  s_nop 0
  v_cvt_pk_bf16_f32 v116, v96, v97
  v_cvt_pk_bf16_f32 v117, v98, v99
  v_cvt_pk_bf16_f32 v118, v100, v101
  v_cvt_pk_bf16_f32 v119, v102, v103
  ds_write_b128 v108, v[116:119] offset:32768
  v_fmamk_f32 v96, v92, 0x41800000, v93
  v_fmamk_f32 v97, v92, 0x41880000, v93
  v_fmamk_f32 v98, v92, 0x41900000, v93
  v_fmamk_f32 v99, v92, 0x41980000, v93
  v_fmamk_f32 v100, v92, 0x41c00000, v93
  v_fmamk_f32 v101, v92, 0x41c80000, v93
  v_fmamk_f32 v102, v92, 0x41d00000, v93
  v_fmamk_f32 v103, v92, 0x41d80000, v93
  v_cos_f32 v96, v96
  v_cos_f32 v97, v97
  v_cos_f32 v98, v98
  v_cos_f32 v99, v99
  v_cos_f32 v100, v100
  v_cos_f32 v101, v101
  v_cos_f32 v102, v102
  v_cos_f32 v103, v103
  s_nop 0
  v_cvt_pk_bf16_f32 v112, v96, v97
  v_cvt_pk_bf16_f32 v113, v98, v99
  v_cvt_pk_bf16_f32 v114, v100, v101
  v_cvt_pk_bf16_f32 v115, v102, v103
  ds_write_b128 v108, v[112:115] offset:33792
  v_mov_b32 v96, v93
  v_fmamk_f32 v97, v92, 0x3f800000, v93
  v_fmamk_f32 v98, v92, 0x40000000, v93
  v_fmamk_f32 v99, v92, 0x40400000, v93
  v_fmamk_f32 v100, v92, 0x41000000, v93
  v_fmamk_f32 v101, v92, 0x41100000, v93
  v_fmamk_f32 v102, v92, 0x41200000, v93
  v_fmamk_f32 v103, v92, 0x41300000, v93
  v_add_f32 v96, 0x3e800000, v96
  v_add_f32 v97, 0x3e800000, v97
  v_add_f32 v98, 0x3e800000, v98
  v_add_f32 v99, 0x3e800000, v99
  v_add_f32 v100, 0x3e800000, v100
  v_add_f32 v101, 0x3e800000, v101
  v_add_f32 v102, 0x3e800000, v102
  v_add_f32 v103, 0x3e800000, v103
  v_cos_f32 v96, v96
  v_cos_f32 v97, v97
  v_cos_f32 v98, v98
  v_cos_f32 v99, v99
  v_cos_f32 v100, v100
  v_cos_f32 v101, v101
  v_cos_f32 v102, v102
  v_cos_f32 v103, v103
  s_nop 0
  v_cvt_pk_bf16_f32 v116, v96, v97
  v_cvt_pk_bf16_f32 v117, v98, v99
  v_cvt_pk_bf16_f32 v118, v100, v101
  v_cvt_pk_bf16_f32 v119, v102, v103
  ds_write_b128 v108, v[116:119] offset:34816
  v_fmamk_f32 v96, v92, 0x41800000, v93
  v_fmamk_f32 v97, v92, 0x41880000, v93
  v_fmamk_f32 v98, v92, 0x41900000, v93
  v_fmamk_f32 v99, v92, 0x41980000, v93
  v_fmamk_f32 v100, v92, 0x41c00000, v93
  v_fmamk_f32 v101, v92, 0x41c80000, v93
  v_fmamk_f32 v102, v92, 0x41d00000, v93
  v_fmamk_f32 v103, v92, 0x41d80000, v93
  v_add_f32 v96, 0x3e800000, v96
  v_add_f32 v97, 0x3e800000, v97
  v_add_f32 v98, 0x3e800000, v98
  v_add_f32 v99, 0x3e800000, v99
  v_add_f32 v100, 0x3e800000, v100
  v_add_f32 v101, 0x3e800000, v101
  v_add_f32 v102, 0x3e800000, v102
  v_add_f32 v103, 0x3e800000, v103
  v_cos_f32 v96, v96
  v_cos_f32 v97, v97
  v_cos_f32 v98, v98
  v_cos_f32 v99, v99
  v_cos_f32 v100, v100
  v_cos_f32 v101, v101
  v_cos_f32 v102, v102
  v_cos_f32 v103, v103
  s_nop 0
  v_cvt_pk_bf16_f32 v112, v96, v97
  v_cvt_pk_bf16_f32 v113, v98, v99
  v_cvt_pk_bf16_f32 v114, v100, v101
  v_cvt_pk_bf16_f32 v115, v102, v103
  ds_write_b128 v108, v[112:115] offset:35840
  s_branch tblend_3
tblend_3:
  s_waitcnt lgkmcnt(0)
  s_barrier
  v_lshlrev_b32 v92, 4, v0
  v_add_u32 v92, 98304, v92
  ds_read_b128 v[20:23], v92 offset:0
  ds_read_b128 v[24:27], v92 offset:1024
  ds_read_b128 v[28:31], v92 offset:2048
  ds_read_b128 v[32:35], v92 offset:3072
  ds_read_b128 v[68:71], v92 offset:12288
  ds_read_b128 v[72:75], v92 offset:13312
  ds_read_b128 v[76:79], v92 offset:14336
  ds_read_b128 v[80:83], v92 offset:15360
  ds_read_b128 v[88:91], v92 offset:16384
  ds_read_b128 v[36:39], v92 offset:4096
  ds_read_b128 v[40:43], v92 offset:5120
  ds_read_b128 v[44:47], v92 offset:6144
  s_waitcnt lgkmcnt(4)
  ds_read_b128 v[48:51], v92 offset:7168
  ds_read_b128 v[52:55], v92 offset:8192
  ds_read_b128 v[56:59], v92 offset:9216
  ds_read_b128 v[60:63], v92 offset:10240
  ds_read_b128 v[64:67], v92 offset:11264
  v_mov_b32 v84, 0xbf803f80
  v_mov_b32 v85, 0xbf803f80
  v_mov_b32 v86, 0xbf803f80
  v_mov_b32 v87, 0xbf803f80
  s_mov_b32 s26, 0xffff0000
  s_waitcnt vmcnt(1)
  s_mul_i32 s20, s17, 8208
  s_lshl_b32 s21, s16, 10
  s_add_u32 s22, s20, s21
  s_add_u32 m0, s21, 33792
  s_nop 0
  buffer_load_dwordx4 v2, s[8:11], s22 offen lds
  s_add_u32 m0, s21, 43008
  s_nop 0
  buffer_load_dwordx4 v2, s[12:15], s22 offen lds
  s_cmp_ge_u32 s16, 2
  s_cbranch_scc1 p1w8_12
  s_mul_i32 s22, s16, 9216
  s_add_u32 m0, s22, 41984
  s_add_u32 s22, s20, 8192
  s_cmp_eq_u32 s16, 0
  s_cbranch_scc0 p1w8a_13
  buffer_load_dwordx4 v2, s[8:11], s22 offen lds
  s_branch p1w8_12
p1w8a_13:
  buffer_load_dwordx4 v2, s[12:15], s22 offen lds
p1w8_12:
  s_cmp_ge_u32 s2, 32
  s_cbranch_scc1 p1b0_14
  s_cmp_lg_u32 s16, 0
  s_cbranch_scc1 p1b0_14
  s_mov_b32 s64, s98
  s_mov_b32 s65, s99
  s_mov_b32 s66, 256
  s_mov_b32 s67, 0x20000
  v_mov_b32 v250, 0
  v_mov_b32 v251, 1
  s_mov_b64 exec, 1
  buffer_atomic_add v251, v250, s[64:67], 0 offen sc1
  s_mov_b64 exec, -1
p1b0_14:
  v_lshlrev_b32 v104, 16, v4
  v_and_b32 v105, s26, v4
  v_lshlrev_b32 v106, 16, v5
  v_and_b32 v107, s26, v5
  v_lshlrev_b32 v108, 16, v6
  v_and_b32 v109, s26, v6
  v_lshlrev_b32 v110, 16, v7
  v_and_b32 v111, s26, v7
  v_lshlrev_b32 v112, 16, v8
  v_and_b32 v113, s26, v8
  v_lshlrev_b32 v114, 16, v9
  v_and_b32 v115, s26, v9
  v_lshlrev_b32 v116, 16, v10
  v_and_b32 v117, s26, v10
  v_lshlrev_b32 v118, 16, v11
  v_and_b32 v119, s26, v11
  v_pk_add_f32 v[140:141], v[104:105], v[106:107]
  v_pk_mul_f32 v[142:143], v[104:105], v[104:105]
  v_pk_fma_f32 v[142:143], v[106:107], v[106:107], v[142:143]
  v_pk_add_f32 v[140:141], v[140:141], v[108:109]
  v_pk_fma_f32 v[142:143], v[108:109], v[108:109], v[142:143]
  v_pk_add_f32 v[140:141], v[140:141], v[110:111]
  v_pk_fma_f32 v[142:143], v[110:111], v[110:111], v[142:143]
  v_pk_add_f32 v[140:141], v[140:141], v[112:113]
  v_pk_fma_f32 v[142:143], v[112:113], v[112:113], v[142:143]
  v_pk_add_f32 v[140:141], v[140:141], v[114:115]
  v_pk_fma_f32 v[142:143], v[114:115], v[114:115], v[142:143]
  v_pk_add_f32 v[140:141], v[140:141], v[116:117]
  v_pk_fma_f32 v[142:143], v[116:117], v[116:117], v[142:143]
  v_pk_add_f32 v[140:141], v[140:141], v[118:119]
  v_pk_fma_f32 v[142:143], v[118:119], v[118:119], v[142:143]
  v_add_f32 v136, v140, v141
  v_add_f32 v137, v142, v143
  s_nop 1
  v_add_f32_dpp v136, v136, v136 row_ror:8 row_mask:0xf bank_mask:0xf
  v_add_f32_dpp v137, v137, v137 row_ror:8 row_mask:0xf bank_mask:0xf
  s_nop 1
  v_add_f32_dpp v136, v136, v136 row_ror:4 row_mask:0xf bank_mask:0xf
  v_add_f32_dpp v137, v137, v137 row_ror:4 row_mask:0xf bank_mask:0xf
  s_nop 1
  v_add_f32_dpp v136, v136, v136 row_ror:2 row_mask:0xf bank_mask:0xf
  v_add_f32_dpp v137, v137, v137 row_ror:2 row_mask:0xf bank_mask:0xf
  s_nop 1
  v_add_f32_dpp v136, v136, v136 row_ror:1 row_mask:0xf bank_mask:0xf
  v_add_f32_dpp v137, v137, v137 row_ror:1 row_mask:0xf bank_mask:0xf
  s_nop 1
  v_mov_b32 v148, v136
  v_mov_b32 v149, v137
  s_nop 1
  v_permlane16_swap_b32 v136, v148
  v_permlane16_swap_b32 v137, v149
  v_add_f32 v136, v136, v148
  v_add_f32 v137, v137, v149
  v_mov_b32 v148, v136
  v_mov_b32 v149, v137
  s_nop 1
  v_permlane32_swap_b32 v136, v148
  v_permlane32_swap_b32 v137, v149
  v_add_f32 v136, v136, v148
  v_add_f32 v137, v137, v149
  v_mul_f32 v136, 0x3a800000, v136
  v_mul_f32 v137, 0x3a800000, v137
  v_fma_f32 v137, -v136, v136, v137
  v_max_f32 v137, 0, v137
  v_cvt_pk_bf16_f32 v136, v136, v136
  v_lshlrev_b32 v136, 16, v136
  v_cvt_pk_bf16_f32 v137, v137, v137
  v_lshlrev_b32 v137, 16, v137
  v_add_f32 v137, 0x3727c5ac, v137
  v_cvt_pk_bf16_f32 v137, v137, v137
  v_lshlrev_b32 v137, 16, v137
  v_sqrt_f32 v137, v137
  s_nop 0
  v_cvt_pk_bf16_f32 v137, v137, v137
  v_lshlrev_b32 v137, 16, v137
  v_rcp_f32 v137, v137
  s_nop 0
  v_sub_f32 v140, 0, v136
  v_mov_b32 v141, v140
  v_mov_b32 v142, v137
  v_mov_b32 v143, v137
  v_pk_add_f32 v[104:105], v[104:105], v[140:141]
  v_pk_mul_f32 v[104:105], v[104:105], v[142:143]
  v_cvt_pk_bf16_f32 v4, v104, v105
  v_pk_add_f32 v[106:107], v[106:107], v[140:141]
  v_pk_mul_f32 v[106:107], v[106:107], v[142:143]
  v_cvt_pk_bf16_f32 v5, v106, v107
  v_pk_add_f32 v[108:109], v[108:109], v[140:141]
  v_pk_mul_f32 v[108:109], v[108:109], v[142:143]
  v_cvt_pk_bf16_f32 v6, v108, v109
  v_pk_add_f32 v[110:111], v[110:111], v[140:141]
  v_pk_mul_f32 v[110:111], v[110:111], v[142:143]
  v_cvt_pk_bf16_f32 v7, v110, v111
  v_pk_add_f32 v[112:113], v[112:113], v[140:141]
  v_pk_mul_f32 v[112:113], v[112:113], v[142:143]
  v_cvt_pk_bf16_f32 v8, v112, v113
  v_pk_add_f32 v[114:115], v[114:115], v[140:141]
  v_pk_mul_f32 v[114:115], v[114:115], v[142:143]
  v_cvt_pk_bf16_f32 v9, v114, v115
  v_pk_add_f32 v[116:117], v[116:117], v[140:141]
  v_pk_mul_f32 v[116:117], v[116:117], v[142:143]
  v_cvt_pk_bf16_f32 v10, v116, v117
  v_pk_add_f32 v[118:119], v[118:119], v[140:141]
  v_pk_mul_f32 v[118:119], v[118:119], v[142:143]
  v_cvt_pk_bf16_f32 v11, v118, v119
  s_lshl_b32 s22, s16, 11
  v_add_u32 v212, s22, v2
  ds_write_b128 v212, v[4:7] offset:0
  ds_write_b128 v212, v[8:11] offset:1024
  v_lshrrev_b32 v96, 5, v0
  v_lshlrev_b32 v96, 3, v96
  v_bfe_u32 v97, v0, 2, 2
  v_add_u32 v96, v96, v97
  v_lshlrev_b32 v96, 6, v96
  v_bfe_u32 v97, v0, 4, 1
  v_lshl_add_u32 v96, v97, 5, v96
  v_and_b32 v97, 3, v0
  v_lshl_add_u32 v96, v97, 3, v96
  v_add_u32 v212, s22, v96
  ds_read_b64_tr_b16 v[104:105], v212 offset:0
  ds_read_b64_tr_b16 v[106:107], v212 offset:256
  ds_read_b64_tr_b16 v[108:109], v212 offset:1024
  ds_read_b64_tr_b16 v[110:111], v212 offset:1280
  s_waitcnt lgkmcnt(2)
  v_mfma_f32_32x32x16_bf16 v[144:159], v[104:107], v[20:23], 0
  v_mfma_f32_32x32x16_bf16 v[160:175], v[104:107], v[28:31], 0
  s_waitcnt lgkmcnt(0)
  v_mfma_f32_32x32x16_bf16 v[144:159], v[108:111], v[24:27], v[144:159]
  v_mfma_f32_32x32x16_bf16 v[160:175], v[108:111], v[32:35], v[160:175]
  v_and_b32 v96, 31, v0
  v_lshlrev_b32 v212, 5, v96
  v_lshrrev_b32 v97, 5, v0
  v_lshl_add_u32 v212, v97, 11, v212
  s_lshr_b32 s22, s16, 2
  v_bfe_u32 v97, v0, 3, 1
  v_xor_b32 v97, s22, v97
  v_lshl_add_u32 v212, v97, 4, v212
  s_and_b32 s22, s16, 3
  s_lshl_b32 s22, s22, 2
  v_add_u32 v212, s22, v212
  s_nop 3
  v_pk_mul_f32 v[208:209], v[144:145], v[36:37]
  v_pk_mul_f32 v[210:211], v[160:161], v[36:37]
  v_pk_fma_f32 v[208:209], v[160:161], v[52:53], v[208:209]
  v_pk_fma_f32 v[210:211], v[144:145], v[52:53], v[210:211] neg_lo:[1,0,0] neg_hi:[1,0,0]
  v_cvt_pk_bf16_f32 v104, v208, v209
  v_cvt_pk_bf16_f32 v112, v210, v211
  v_pk_mul_f32 v[208:209], v[146:147], v[38:39]
  v_pk_mul_f32 v[210:211], v[162:163], v[38:39]
  v_pk_fma_f32 v[208:209], v[162:163], v[54:55], v[208:209]
  v_pk_fma_f32 v[210:211], v[146:147], v[54:55], v[210:211] neg_lo:[1,0,0] neg_hi:[1,0,0]
  v_cvt_pk_bf16_f32 v105, v208, v209
  v_cvt_pk_bf16_f32 v113, v210, v211
  v_pk_mul_f32 v[208:209], v[148:149], v[40:41]
  v_pk_mul_f32 v[210:211], v[164:165], v[40:41]
  v_pk_fma_f32 v[208:209], v[164:165], v[56:57], v[208:209]
  v_pk_fma_f32 v[210:211], v[148:149], v[56:57], v[210:211] neg_lo:[1,0,0] neg_hi:[1,0,0]
  v_cvt_pk_bf16_f32 v106, v208, v209
  v_cvt_pk_bf16_f32 v114, v210, v211
  v_pk_mul_f32 v[208:209], v[150:151], v[42:43]
  v_pk_mul_f32 v[210:211], v[166:167], v[42:43]
  v_pk_fma_f32 v[208:209], v[166:167], v[58:59], v[208:209]
  v_pk_fma_f32 v[210:211], v[150:151], v[58:59], v[210:211] neg_lo:[1,0,0] neg_hi:[1,0,0]
  v_cvt_pk_bf16_f32 v107, v208, v209
  v_cvt_pk_bf16_f32 v115, v210, v211
  v_pk_mul_f32 v[208:209], v[152:153], v[44:45]
  v_pk_mul_f32 v[210:211], v[168:169], v[44:45]
  v_pk_fma_f32 v[208:209], v[168:169], v[60:61], v[208:209]
  v_pk_fma_f32 v[210:211], v[152:153], v[60:61], v[210:211] neg_lo:[1,0,0] neg_hi:[1,0,0]
  v_cvt_pk_bf16_f32 v108, v208, v209
  v_cvt_pk_bf16_f32 v116, v210, v211
  v_pk_mul_f32 v[208:209], v[154:155], v[46:47]
  v_pk_mul_f32 v[210:211], v[170:171], v[46:47]
  v_pk_fma_f32 v[208:209], v[170:171], v[62:63], v[208:209]
  v_pk_fma_f32 v[210:211], v[154:155], v[62:63], v[210:211] neg_lo:[1,0,0] neg_hi:[1,0,0]
  v_cvt_pk_bf16_f32 v109, v208, v209
  v_cvt_pk_bf16_f32 v117, v210, v211
  v_pk_mul_f32 v[208:209], v[156:157], v[48:49]
  v_pk_mul_f32 v[210:211], v[172:173], v[48:49]
  v_pk_fma_f32 v[208:209], v[172:173], v[64:65], v[208:209]
  v_pk_fma_f32 v[210:211], v[156:157], v[64:65], v[210:211] neg_lo:[1,0,0] neg_hi:[1,0,0]
  v_cvt_pk_bf16_f32 v110, v208, v209
  v_cvt_pk_bf16_f32 v118, v210, v211
  v_pk_mul_f32 v[208:209], v[158:159], v[50:51]
  v_pk_mul_f32 v[210:211], v[174:175], v[50:51]
  v_pk_fma_f32 v[208:209], v[174:175], v[66:67], v[208:209]
  v_pk_fma_f32 v[210:211], v[158:159], v[66:67], v[210:211] neg_lo:[1,0,0] neg_hi:[1,0,0]
  v_cvt_pk_bf16_f32 v111, v208, v209
  v_cvt_pk_bf16_f32 v119, v210, v211
  s_nop 1
  v_mfma_f32_32x32x16_bf16 v[144:159], v[68:71], v[104:107], 0
  v_mfma_f32_32x32x16_bf16 v[160:175], v[84:87], v[104:107], 0
  v_mfma_f32_32x32x16_bf16 v[144:159], v[72:75], v[108:111], v[144:159]
  v_mfma_f32_32x32x16_bf16 v[160:175], v[84:87], v[108:111], v[160:175]
  v_mfma_f32_32x32x16_bf16 v[144:159], v[76:79], v[112:115], v[144:159]
  v_mfma_f32_32x32x16_bf16 v[144:159], v[80:83], v[116:119], v[144:159]
  s_nop 11
  v_cvt_pk_bf16_f32 v4, v144, v145
  v_cvt_pk_bf16_f32 v5, v146, v147
  v_cvt_pk_bf16_f32 v6, v148, v149
  v_cvt_pk_bf16_f32 v7, v150, v151
  v_cvt_pk_bf16_f32 v8, v152, v153
  v_cvt_pk_bf16_f32 v9, v154, v155
  v_cvt_pk_bf16_f32 v10, v156, v157
  v_cvt_pk_bf16_f32 v11, v158, v159
  ds_write_b32 v212, v4 offset:16384
  ds_write_b32 v212, v5 offset:17408
  ds_write_b32 v212, v6 offset:20480
  ds_write_b32 v212, v7 offset:21504
  ds_write_b32 v212, v8 offset:24576
  ds_write_b32 v212, v9 offset:25600
  ds_write_b32 v212, v10 offset:28672
  ds_write_b32 v212, v11 offset:29696
  v_cvt_pk_bf16_f32 v208, v160, 0
  s_lshl_b32 s22, s16, 2
  v_mov_b32 v210, s22
  s_mov_b64 exec, 1
  ds_write_b32 v210, v208 offset:32768
  s_mov_b64 exec, -1
  s_waitcnt lgkmcnt(0)
  s_barrier
  s_mov_b32 s64, s98
  s_mov_b32 s65, s99
  s_mov_b32 s66, 256
  s_mov_b32 s67, 0x20000
  v_mov_b32 v250, 0
  buffer_load_dword v252, v250, s[64:67], 0 offen sc1
  s_mov_b32 s48, s30
  s_mov_b32 s49, s31
  s_mov_b32 s50, 4276480
  s_mov_b32 s51, 0x20000
  s_add_u32 s52, s30, 8388608
  s_addc_u32 s53, s31, 0
  s_mov_b32 s54, 4276480
  s_mov_b32 s55, 0x20000
  v_and_b32 v96, 31, v0
  v_lshlrev_b32 v212, 5, v96
  v_lshrrev_b32 v97, 5, v0
  v_bfe_u32 v98, v0, 3, 1
  v_xor_b32 v97, v97, v98
  v_lshl_add_u32 v212, v97, 4, v212
  v_mov_b32 v214, v212
  s_lshl_b32 s22, s16, 11
  v_add_u32 v212, s22, v212
  ds_read_b128 v[104:107], v212 offset:16384
  ds_read_b128 v[108:111], v212 offset:17408
  ds_read_b128 v[112:115], v214 offset:32768
  v_bfe_u32 v96, v0, 1, 4
  s_mov_b32 s22, 16640
  v_mul_lo_u32 v213, v96, s22
  v_and_b32 v96, 1, v0
  v_lshl_add_u32 v213, v96, 5, v213
  v_lshrrev_b32 v96, 5, v0
  v_lshl_add_u32 v213, v96, 4, v213
  s_mul_i32 s22, s16, 532480
  s_lshl_b32 s23, s17, 6
  s_add_u32 s22, s22, s23
  s_waitcnt lgkmcnt(2)
  v_mfma_f32_32x32x16_bf16 v[144:159], v[88:91], v[104:107], 0
  s_waitcnt lgkmcnt(1)
  v_mfma_f32_32x32x16_bf16 v[160:175], v[88:91], v[108:111], 0
  s_waitcnt lgkmcnt(0)
  v_mfma_f32_32x32x16_bf16 v[176:191], v[88:91], v[112:115], 0
  v_and_b32 v96, 1, v1
  v_mul_u32_u24 v214, 4104, v96
  v_lshrrev_b32 v96, 2, v1
  v_lshl_add_u32 v214, v96, 2, v214
  v_bfe_u32 v97, v1, 1, 1
  v_lshl_add_u32 v214, v97, 1, v214
  s_mov_b32 s24, 16640
  v_mul_lo_u32 v215, v96, s24
  v_and_b32 v96, 3, v1
  v_lshl_add_u32 v215, v96, 4, v215
  s_nop 1
  v_cvt_pk_bf16_f32 v4, v144, v145
  v_cvt_pk_bf16_f32 v5, v146, v147
  v_cvt_pk_bf16_f32 v6, v148, v149
  v_cvt_pk_bf16_f32 v7, v150, v151
  buffer_store_dwordx4 v[4:7], v213, s[48:51], s22 offen sc1
  s_add_u32 s22, s22, 266240
  v_cvt_pk_bf16_f32 v8, v160, v161
  v_cvt_pk_bf16_f32 v9, v162, v163
  v_cvt_pk_bf16_f32 v10, v164, v165
  v_cvt_pk_bf16_f32 v11, v166, v167
  buffer_store_dwordx4 v[8:11], v213, s[48:51], s22 offen sc1
  s_add_u32 s22, s22, 266240
  s_cmp_lg_u32 s16, 7
  s_cbranch_scc1 p1ny_15
  v_cvt_pk_bf16_f32 v12, v176, v177
  v_cvt_pk_bf16_f32 v13, v178, v179
  v_cvt_pk_bf16_f32 v14, v180, v181
  v_cvt_pk_bf16_f32 v15, v182, v183
  s_lshl_b32 s22, s17, 5
  s_add_u32 s22, s22, 4259840
  v_lshrrev_b32 v96, 5, v0
  v_lshlrev_b32 v96, 4, v96
  s_mov_b32 exec_lo, 1
  s_mov_b32 exec_hi, 1
  buffer_store_dwordx4 v[12:15], v96, s[48:51], s22 offen sc1
  s_mov_b64 exec, -1
p1ny_15:
  s_waitcnt vmcnt(3)
  s_barrier
  ds_read_u16 v120, v214 offset:33792
  ds_read_u16 v128, v214 offset:43008
  ds_read_u16 v121, v214 offset:34818
  ds_read_u16 v129, v214 offset:44034
  ds_read_u16 v122, v214 offset:35844
  ds_read_u16 v130, v214 offset:45060
  ds_read_u16 v123, v214 offset:36870
  ds_read_u16 v131, v214 offset:46086
  s_waitcnt lgkmcnt(7)
  ds_read_u16 v124, v214 offset:34304
  ds_read_u16 v132, v214 offset:43520
  ds_read_u16 v125, v214 offset:35330
  ds_read_u16 v133, v214 offset:44546
  ds_read_u16 v126, v214 offset:36356
  ds_read_u16 v134, v214 offset:45572
  ds_read_u16 v127, v214 offset:37382
  ds_read_u16 v135, v214 offset:46598
  s_waitcnt lgkmcnt(0)
  v_lshl_or_b32 v120, v128, 16, v120
  v_lshl_or_b32 v121, v129, 16, v121
  v_lshl_or_b32 v122, v130, 16, v122
  v_lshl_or_b32 v123, v131, 16, v123
  v_lshl_or_b32 v124, v132, 16, v124
  v_lshl_or_b32 v125, v133, 16, v125
  v_lshl_or_b32 v126, v134, 16, v126
  v_lshl_or_b32 v127, v135, 16, v127
  s_lshl_b32 s22, s17, 6
  buffer_store_dwordx4 v[120:123], v215, s[52:55], s22 offen sc1
  s_add_u32 s22, s22, 2129920
  buffer_store_dwordx4 v[124:127], v215, s[52:55], s22 offen sc1
  s_add_u32 s22, s22, 2129920
  s_cmp_lg_u32 s16, 0
  s_cbranch_scc1 p1we_16
  s_mov_b64 exec, 3
  ds_read_u16 v104, v214 offset:34816
  ds_read_u16 v108, v214 offset:44032
  ds_read_u16 v105, v214 offset:35842
  ds_read_u16 v109, v214 offset:45058
  ds_read_u16 v106, v214 offset:36868
  ds_read_u16 v110, v214 offset:46084
  ds_read_u16 v107, v214 offset:37894
  ds_read_u16 v111, v214 offset:47110
  s_waitcnt lgkmcnt(0)
  v_lshl_or_b32 v104, v108, 16, v104
  v_lshl_or_b32 v105, v109, 16, v105
  v_lshl_or_b32 v106, v110, 16, v106
  v_lshl_or_b32 v107, v111, 16, v107
  s_lshl_b32 s22, s17, 5
  s_add_u32 s22, s22, 4259840
  v_lshlrev_b32 v96, 4, v0
  buffer_store_dwordx4 v[104:107], v96, s[52:55], s22 offen sc1
  s_mov_b64 exec, -1
p1we_16:
  s_waitcnt vmcnt(2) lgkmcnt(0)
  s_barrier
  s_cmp_lg_u32 s16, 0
  s_cbranch_scc1 arr_17
  s_mov_b32 s64, s98
  s_mov_b32 s65, s99
  s_mov_b32 s66, 256
  s_mov_b32 s67, 0x20000
  s_mov_b32 s3, 0x20000
  v_mov_b32 v250, 0
b0p_18:
  v_cmp_le_u32 vcc, 32, v252
  s_sub_u32 s3, s3, 1
  s_cbranch_scc1 b0d_19
  s_cmp_lg_u64 vcc, 0
  s_cbranch_scc1 b0d_19
  buffer_load_dword v252, v250, s[64:67], 0 offen sc1
  s_waitcnt vmcnt(0)
  s_branch b0p_18
b0d_19:
  s_add_u32 s64, s30, 71303168
  s_addc_u32 s65, s31, 0
  s_mov_b32 s66, 32768
  s_mov_b32 s67, 0x20000
  s_and_b32 s3, s2, 15
  s_lshl_b32 s3, s3, 8
  v_lshlrev_b32 v250, 12, v0
  v_add_u32 v250, s3, v250
  v_mov_b32 v251, 1
  s_mov_b64 exec, 0xff
  buffer_atomic_add v251, v250, s[64:67], 0 offen sc1
  s_mov_b64 exec, -1
arr_17:
  s_waitcnt vmcnt(0) lgkmcnt(0)
  s_barrier
  s_cmp_lg_u32 s16, 0
  s_cbranch_scc1 arr_20
  s_add_u32 s64, s30, 71335936
  s_addc_u32 s65, s31, 0
  s_mov_b32 s66, 32768
  s_mov_b32 s67, 0x20000
  s_and_b32 s3, s2, 15
  s_lshl_b32 s3, s3, 8
  v_lshlrev_b32 v250, 12, v0
  v_add_u32 v250, s3, v250
  v_mov_b32 v251, 1
  s_mov_b64 exec, 0xff
  buffer_atomic_add v251, v250, s[64:67], 0 offen sc1
  s_mov_b64 exec, -1
arr_20:
  s_and_b32 s20, s16, 3
  s_cmp_lt_u32 s16, 4
  s_cselect_b32 s19, 1, 0
  s_cmp_lg_u32 s2, 0
  s_cbranch_scc1 p2ny_21
  s_cmp_lt_u32 s16, 4
  s_cbranch_scc1 p2ny_21
  s_mov_b32 s19, 2
p2ny_21:
  s_cmp_eq_u32 s19, 0
  s_cbranch_scc1 p2nt_22
  v_and_b32 v36, 15, v0
  v_lshrrev_b32 v37, 4, v0
  v_lshlrev_b32 v80, 4, v0
  v_add_u32 v80, 98304, v80
  ds_read_b128 v[40:43], v80 offset:17408
  ds_read_b128 v[44:47], v80 offset:18432
  ds_read_b128 v[56:59], v80 offset:19456
  ds_read_b128 v[60:63], v80 offset:20480
  ds_read_b128 v[72:75], v80 offset:21504
  ds_read_b128 v[76:79], v80 offset:22528
  ds_read_b128 v[48:51], v80 offset:23552
  ds_read_b128 v[52:55], v80 offset:25600
  ds_read_b128 v[64:67], v80 offset:24576
  ds_read_b128 v[68:71], v80 offset:26624
  s_mov_b32 s4, s30
  s_mov_b32 s5, s31
  s_mov_b32 s6, 4276480
  s_mov_b32 s7, 0x20000
  s_add_u32 s8, s30, 8388608
  s_addc_u32 s9, s31, 0
  s_mov_b32 s10, 4276480
  s_mov_b32 s11, 0x20000
  s_add_u32 s12, s30, 16777216
  s_addc_u32 s13, s31, 0
  s_mov_b32 s14, 4276480
  s_mov_b32 s15, 0x20000
  s_mul_i32 s18, s2, 16640
  v_lshrrev_b32 v38, 2, v36
  v_xor_b32 v38, s20, v38
  v_lshlrev_b32 v38, 4, v38
  v_lshl_add_u32 v32, v37, 6, v36
  v_lshl_add_u32 v32, v32, 6, v38
  v_lshl_add_u32 v33, v37, 5, v36
  v_lshl_add_u32 v33, v33, 6, v38
  v_and_b32 v38, 3, v0
  v_xor_b32 v38, v38, v37
  v_lshrrev_b32 v39, 2, v0
  v_lshlrev_b32 v39, 6, v39
  v_lshl_add_u32 v31, v38, 4, v39
  v_lshl_add_u32 v34, v37, 6, v36
  v_lshlrev_b32 v34, 5, v34
  s_lshl_b32 s21, s20, 3
  s_add_u32 s21, s21, 49152
  v_add_u32 v34, s21, v34
  v_lshl_add_u32 v35, v37, 5, v36
  v_lshlrev_b32 v35, 5, v35
  v_add_u32 v35, s21, v35
p2nt_22:
  s_cmp_lg_u32 s16, 0
  s_cbranch_scc1 pw_23
  s_add_u32 s64, s30, 71303168
  s_addc_u32 s65, s31, 0
  s_mov_b32 s66, 32768
  s_mov_b32 s67, 0x20000
  s_bfe_u32 s3, s2, 0x30004
  s_lshl_b32 s3, s3, 12
  v_and_b32 v250, 15, v0
  v_lshlrev_b32 v250, 8, v250
  v_add_u32 v250, s3, v250
  s_mov_b32 s3, 0x20000
  buffer_load_dword v251, v250, s[64:67], 0 offen sc1
pl_24:
  s_waitcnt vmcnt(0)
  v_cmp_gt_u32 vcc, 16, v251
  s_sub_u32 s3, s3, 1
  s_cbranch_scc1 pd_25
  s_cmp_eq_u64 vcc, 0
  s_cbranch_scc1 pd_25
  s_sleep 1
  buffer_load_dword v251, v250, s[64:67], 0 offen sc1
  s_branch pl_24
pd_25:
pw_23:
  s_barrier
  s_cmp_eq_u32 s19, 2
  s_cbranch_scc1 pfb_26
pfb_26:
  s_cmp_eq_u32 s19, 0
  s_cbranch_scc1 p2idle_27
  s_cmp_eq_u32 s19, 2
  s_cbranch_scc1 p2nyq_29
  s_lshl_b32 s22, s20, 12
  s_add_u32 s23, s22, s18
  s_add_u32 m0, s22, 0
  s_add_u32 s24, s23, 0
  buffer_load_dwordx4 v31, s[4:7], s24 offen sc1 lds
  s_add_u32 m0, s22, 1024
  s_add_u32 s24, s23, 1024
  buffer_load_dwordx4 v31, s[4:7], s24 offen sc1 lds
  s_add_u32 m0, s22, 2048
  s_add_u32 s24, s23, 2048
  buffer_load_dwordx4 v31, s[4:7], s24 offen sc1 lds
  s_add_u32 m0, s22, 3072
  s_add_u32 s24, s23, 3072
  buffer_load_dwordx4 v31, s[4:7], s24 offen sc1 lds
  s_barrier
  s_add_u32 m0, s22, 16384
  s_add_u32 s24, s23, 0
  buffer_load_dwordx4 v31, s[8:11], s24 offen sc1 lds
  s_add_u32 m0, s22, 17408
  s_add_u32 s24, s23, 1024
  buffer_load_dwordx4 v31, s[8:11], s24 offen sc1 lds
  s_add_u32 m0, s22, 18432
  s_add_u32 s24, s23, 2048
  buffer_load_dwordx4 v31, s[8:11], s24 offen sc1 lds
  s_add_u32 m0, s22, 19456
  s_add_u32 s24, s23, 3072
  buffer_load_dwordx4 v31, s[8:11], s24 offen sc1 lds
  s_waitcnt vmcnt(4)
  s_barrier
  ds_read_b128 v[4:7], v32 offset:0
  ds_read_b128 v[8:11], v32 offset:1024
  ds_read_b128 v[12:15], v32 offset:2048
  ds_read_b128 v[16:19], v32 offset:3072
  s_waitcnt lgkmcnt(0)
  v_swap_b32 v5, v8
  v_swap_b32 v6, v12
  v_swap_b32 v7, v16
  v_swap_b32 v10, v13
  v_swap_b32 v11, v17
  v_swap_b32 v15, v18
  s_nop 1
  v_mfma_f32_16x16x32_bf16 v[112:115], v[4:7], v[40:43], 0
  v_mfma_f32_16x16x32_bf16 v[116:119], v[4:7], v[44:47], 0
  v_mfma_f32_16x16x32_bf16 v[120:123], v[8:11], v[40:43], 0
  v_mfma_f32_16x16x32_bf16 v[124:127], v[8:11], v[44:47], 0
  v_mfma_f32_16x16x32_bf16 v[128:131], v[12:15], v[40:43], 0
  v_mfma_f32_16x16x32_bf16 v[132:135], v[12:15], v[44:47], 0
  v_mfma_f32_16x16x32_bf16 v[136:139], v[16:19], v[40:43], 0
  v_mfma_f32_16x16x32_bf16 v[140:143], v[16:19], v[44:47], 0
  s_nop 3
  v_pk_mul_f32 v[144:145], v[112:113], v[72:73]
  v_pk_mul_f32 v[148:149], v[116:117], v[72:73]
  v_pk_mul_f32 v[146:147], v[114:115], v[74:75]
  v_pk_mul_f32 v[150:151], v[118:119], v[74:75]
  v_pk_fma_f32 v[144:145], v[116:117], v[76:77], v[144:145]
  v_pk_fma_f32 v[148:149], v[112:113], v[76:77], v[148:149] neg_lo:[1,0,0] neg_hi:[1,0,0]
  v_pk_fma_f32 v[146:147], v[118:119], v[78:79], v[146:147]
  v_pk_fma_f32 v[150:151], v[114:115], v[78:79], v[150:151] neg_lo:[1,0,0] neg_hi:[1,0,0]
  v_cvt_pk_bf16_f32 v4, v144, v148
  v_cvt_pk_bf16_f32 v5, v145, v149
  v_cvt_pk_bf16_f32 v6, v146, v150
  v_cvt_pk_bf16_f32 v7, v147, v151
  v_pk_mul_f32 v[144:145], v[120:121], v[72:73]
  v_pk_mul_f32 v[148:149], v[124:125], v[72:73]
  v_pk_mul_f32 v[146:147], v[122:123], v[74:75]
  v_pk_mul_f32 v[150:151], v[126:127], v[74:75]
  v_pk_fma_f32 v[144:145], v[124:125], v[76:77], v[144:145]
  v_pk_fma_f32 v[148:149], v[120:121], v[76:77], v[148:149] neg_lo:[1,0,0] neg_hi:[1,0,0]
  v_pk_fma_f32 v[146:147], v[126:127], v[78:79], v[146:147]
  v_pk_fma_f32 v[150:151], v[122:123], v[78:79], v[150:151] neg_lo:[1,0,0] neg_hi:[1,0,0]
  v_cvt_pk_bf16_f32 v8, v144, v148
  v_cvt_pk_bf16_f32 v9, v145, v149
  v_cvt_pk_bf16_f32 v10, v146, v150
  v_cvt_pk_bf16_f32 v11, v147, v151
  v_pk_mul_f32 v[144:145], v[128:129], v[72:73]
  v_pk_mul_f32 v[148:149], v[132:133], v[72:73]
  v_pk_mul_f32 v[146:147], v[130:131], v[74:75]
  v_pk_mul_f32 v[150:151], v[134:135], v[74:75]
  v_pk_fma_f32 v[144:145], v[132:133], v[76:77], v[144:145]
  v_pk_fma_f32 v[148:149], v[128:129], v[76:77], v[148:149] neg_lo:[1,0,0] neg_hi:[1,0,0]
  v_pk_fma_f32 v[146:147], v[134:135], v[78:79], v[146:147]
  v_pk_fma_f32 v[150:151], v[130:131], v[78:79], v[150:151] neg_lo:[1,0,0] neg_hi:[1,0,0]
  v_cvt_pk_bf16_f32 v12, v144, v148
  v_cvt_pk_bf16_f32 v13, v145, v149
  v_cvt_pk_bf16_f32 v14, v146, v150
  v_cvt_pk_bf16_f32 v15, v147, v151
  v_pk_mul_f32 v[144:145], v[136:137], v[72:73]
  v_pk_mul_f32 v[148:149], v[140:141], v[72:73]
  v_pk_mul_f32 v[146:147], v[138:139], v[74:75]
  v_pk_mul_f32 v[150:151], v[142:143], v[74:75]
  v_pk_fma_f32 v[144:145], v[140:141], v[76:77], v[144:145]
  v_pk_fma_f32 v[148:149], v[136:137], v[76:77], v[148:149] neg_lo:[1,0,0] neg_hi:[1,0,0]
  v_pk_fma_f32 v[146:147], v[142:143], v[78:79], v[146:147]
  v_pk_fma_f32 v[150:151], v[138:139], v[78:79], v[150:151] neg_lo:[1,0,0] neg_hi:[1,0,0]
  v_cvt_pk_bf16_f32 v16, v144, v148
  v_cvt_pk_bf16_f32 v17, v145, v149
  v_cvt_pk_bf16_f32 v18, v146, v150
  v_cvt_pk_bf16_f32 v19, v147, v151
  s_nop 1
  v_mfma_f32_16x16x32_bf16 v[112:115], v[48:51], v[4:7], 0
  v_mfma_f32_16x16x32_bf16 v[116:119], v[52:55], v[4:7], 0
  v_mfma_f32_16x16x32_bf16 v[120:123], v[48:51], v[8:11], 0
  v_mfma_f32_16x16x32_bf16 v[124:127], v[52:55], v[8:11], 0
  v_mfma_f32_16x16x32_bf16 v[128:131], v[48:51], v[12:15], 0
  v_mfma_f32_16x16x32_bf16 v[132:135], v[52:55], v[12:15], 0
  v_mfma_f32_16x16x32_bf16 v[136:139], v[48:51], v[16:19], 0
  v_mfma_f32_16x16x32_bf16 v[140:143], v[52:55], v[16:19], 0
  s_mov_b32 s26, 0xffff0000
  s_waitcnt vmcnt(0)
  s_barrier
  ds_read_b128 v[96:99], v33 offset:16384
  ds_read_b128 v[100:103], v33 offset:17408
  ds_read_b128 v[104:107], v33 offset:24576
  ds_read_b128 v[108:111], v33 offset:25600
  s_waitcnt lgkmcnt(0)
  s_nop 2
  v_lshlrev_b32 v144, 16, v96
  v_and_b32 v145, s26, v96
  v_pk_mul_f32 v[146:147], v[112:113], v[144:145] op_sel:[0,0] op_sel_hi:[1,0]
  v_pk_fma_f32 v[146:147], v[112:113], v[144:145], v[146:147] op_sel:[1,1,0] op_sel_hi:[0,1,1] neg_lo:[1,0,0]
  v_cvt_pk_bf16_f32 v4, v146, v147
  v_lshlrev_b32 v144, 16, v100
  v_and_b32 v145, s26, v100
  v_pk_mul_f32 v[146:147], v[114:115], v[144:145] op_sel:[0,0] op_sel_hi:[1,0]
  v_pk_fma_f32 v[146:147], v[114:115], v[144:145], v[146:147] op_sel:[1,1,0] op_sel_hi:[0,1,1] neg_lo:[1,0,0]
  v_cvt_pk_bf16_f32 v5, v146, v147
  v_lshlrev_b32 v144, 16, v104
  v_and_b32 v145, s26, v104
  v_pk_mul_f32 v[146:147], v[116:117], v[144:145] op_sel:[0,0] op_sel_hi:[1,0]
  v_pk_fma_f32 v[146:147], v[116:117], v[144:145], v[146:147] op_sel:[1,1,0] op_sel_hi:[0,1,1] neg_lo:[1,0,0]
  v_cvt_pk_bf16_f32 v6, v146, v147
  v_lshlrev_b32 v144, 16, v108
  v_and_b32 v145, s26, v108
  v_pk_mul_f32 v[146:147], v[118:119], v[144:145] op_sel:[0,0] op_sel_hi:[1,0]
  v_pk_fma_f32 v[146:147], v[118:119], v[144:145], v[146:147] op_sel:[1,1,0] op_sel_hi:[0,1,1] neg_lo:[1,0,0]
  v_cvt_pk_bf16_f32 v7, v146, v147
  v_lshlrev_b32 v144, 16, v97
  v_and_b32 v145, s26, v97
  v_pk_mul_f32 v[146:147], v[120:121], v[144:145] op_sel:[0,0] op_sel_hi:[1,0]
  v_pk_fma_f32 v[146:147], v[120:121], v[144:145], v[146:147] op_sel:[1,1,0] op_sel_hi:[0,1,1] neg_lo:[1,0,0]
  v_cvt_pk_bf16_f32 v8, v146, v147
  v_lshlrev_b32 v144, 16, v101
  v_and_b32 v145, s26, v101
  v_pk_mul_f32 v[146:147], v[122:123], v[144:145] op_sel:[0,0] op_sel_hi:[1,0]
  v_pk_fma_f32 v[146:147], v[122:123], v[144:145], v[146:147] op_sel:[1,1,0] op_sel_hi:[0,1,1] neg_lo:[1,0,0]
  v_cvt_pk_bf16_f32 v9, v146, v147
  v_lshlrev_b32 v144, 16, v105
  v_and_b32 v145, s26, v105
  v_pk_mul_f32 v[146:147], v[124:125], v[144:145] op_sel:[0,0] op_sel_hi:[1,0]
  v_pk_fma_f32 v[146:147], v[124:125], v[144:145], v[146:147] op_sel:[1,1,0] op_sel_hi:[0,1,1] neg_lo:[1,0,0]
  v_cvt_pk_bf16_f32 v10, v146, v147
  v_lshlrev_b32 v144, 16, v109
  v_and_b32 v145, s26, v109
  v_pk_mul_f32 v[146:147], v[126:127], v[144:145] op_sel:[0,0] op_sel_hi:[1,0]
  v_pk_fma_f32 v[146:147], v[126:127], v[144:145], v[146:147] op_sel:[1,1,0] op_sel_hi:[0,1,1] neg_lo:[1,0,0]
  v_cvt_pk_bf16_f32 v11, v146, v147
  v_lshlrev_b32 v144, 16, v98
  v_and_b32 v145, s26, v98
  v_pk_mul_f32 v[146:147], v[128:129], v[144:145] op_sel:[0,0] op_sel_hi:[1,0]
  v_pk_fma_f32 v[146:147], v[128:129], v[144:145], v[146:147] op_sel:[1,1,0] op_sel_hi:[0,1,1] neg_lo:[1,0,0]
  v_cvt_pk_bf16_f32 v12, v146, v147
  v_lshlrev_b32 v144, 16, v102
  v_and_b32 v145, s26, v102
  v_pk_mul_f32 v[146:147], v[130:131], v[144:145] op_sel:[0,0] op_sel_hi:[1,0]
  v_pk_fma_f32 v[146:147], v[130:131], v[144:145], v[146:147] op_sel:[1,1,0] op_sel_hi:[0,1,1] neg_lo:[1,0,0]
  v_cvt_pk_bf16_f32 v13, v146, v147
  v_lshlrev_b32 v144, 16, v106
  v_and_b32 v145, s26, v106
  v_pk_mul_f32 v[146:147], v[132:133], v[144:145] op_sel:[0,0] op_sel_hi:[1,0]
  v_pk_fma_f32 v[146:147], v[132:133], v[144:145], v[146:147] op_sel:[1,1,0] op_sel_hi:[0,1,1] neg_lo:[1,0,0]
  v_cvt_pk_bf16_f32 v14, v146, v147
  v_lshlrev_b32 v144, 16, v110
  v_and_b32 v145, s26, v110
  v_pk_mul_f32 v[146:147], v[134:135], v[144:145] op_sel:[0,0] op_sel_hi:[1,0]
  v_pk_fma_f32 v[146:147], v[134:135], v[144:145], v[146:147] op_sel:[1,1,0] op_sel_hi:[0,1,1] neg_lo:[1,0,0]
  v_cvt_pk_bf16_f32 v15, v146, v147
  v_lshlrev_b32 v144, 16, v99
  v_and_b32 v145, s26, v99
  v_pk_mul_f32 v[146:147], v[136:137], v[144:145] op_sel:[0,0] op_sel_hi:[1,0]
  v_pk_fma_f32 v[146:147], v[136:137], v[144:145], v[146:147] op_sel:[1,1,0] op_sel_hi:[0,1,1] neg_lo:[1,0,0]
  v_cvt_pk_bf16_f32 v16, v146, v147
  v_lshlrev_b32 v144, 16, v103
  v_and_b32 v145, s26, v103
  v_pk_mul_f32 v[146:147], v[138:139], v[144:145] op_sel:[0,0] op_sel_hi:[1,0]
  v_pk_fma_f32 v[146:147], v[138:139], v[144:145], v[146:147] op_sel:[1,1,0] op_sel_hi:[0,1,1] neg_lo:[1,0,0]
  v_cvt_pk_bf16_f32 v17, v146, v147
  v_lshlrev_b32 v144, 16, v107
  v_and_b32 v145, s26, v107
  v_pk_mul_f32 v[146:147], v[140:141], v[144:145] op_sel:[0,0] op_sel_hi:[1,0]
  v_pk_fma_f32 v[146:147], v[140:141], v[144:145], v[146:147] op_sel:[1,1,0] op_sel_hi:[0,1,1] neg_lo:[1,0,0]
  v_cvt_pk_bf16_f32 v18, v146, v147
  v_lshlrev_b32 v144, 16, v111
  v_and_b32 v145, s26, v111
  v_pk_mul_f32 v[146:147], v[142:143], v[144:145] op_sel:[0,0] op_sel_hi:[1,0]
  v_pk_fma_f32 v[146:147], v[142:143], v[144:145], v[146:147] op_sel:[1,1,0] op_sel_hi:[0,1,1] neg_lo:[1,0,0]
  v_cvt_pk_bf16_f32 v19, v146, v147
  s_nop 1
  v_mfma_f32_16x16x32_bf16 v[112:115], v[4:7], v[56:59], 0
  v_mfma_f32_16x16x32_bf16 v[116:119], v[4:7], v[60:63], 0
  v_mfma_f32_16x16x32_bf16 v[120:123], v[8:11], v[56:59], 0
  v_mfma_f32_16x16x32_bf16 v[124:127], v[8:11], v[60:63], 0
  v_mfma_f32_16x16x32_bf16 v[128:131], v[12:15], v[56:59], 0
  v_mfma_f32_16x16x32_bf16 v[132:135], v[12:15], v[60:63], 0
  v_mfma_f32_16x16x32_bf16 v[136:139], v[16:19], v[56:59], 0
  v_mfma_f32_16x16x32_bf16 v[140:143], v[16:19], v[60:63], 0
  s_nop 3
  v_pk_mul_f32 v[144:145], v[112:113], v[72:73]
  v_pk_mul_f32 v[148:149], v[116:117], v[72:73]
  v_pk_mul_f32 v[146:147], v[114:115], v[74:75]
  v_pk_mul_f32 v[150:151], v[118:119], v[74:75]
  v_pk_fma_f32 v[144:145], v[116:117], v[76:77], v[144:145] neg_lo:[1,0,0] neg_hi:[1,0,0]
  v_pk_fma_f32 v[148:149], v[112:113], v[76:77], v[148:149]
  v_pk_fma_f32 v[146:147], v[118:119], v[78:79], v[146:147] neg_lo:[1,0,0] neg_hi:[1,0,0]
  v_pk_fma_f32 v[150:151], v[114:115], v[78:79], v[150:151]
  v_cvt_pk_bf16_f32 v4, v144, v148
  v_cvt_pk_bf16_f32 v5, v145, v149
  v_cvt_pk_bf16_f32 v6, v146, v150
  v_cvt_pk_bf16_f32 v7, v147, v151
  v_pk_mul_f32 v[144:145], v[120:121], v[72:73]
  v_pk_mul_f32 v[148:149], v[124:125], v[72:73]
  v_pk_mul_f32 v[146:147], v[122:123], v[74:75]
  v_pk_mul_f32 v[150:151], v[126:127], v[74:75]
  v_pk_fma_f32 v[144:145], v[124:125], v[76:77], v[144:145] neg_lo:[1,0,0] neg_hi:[1,0,0]
  v_pk_fma_f32 v[148:149], v[120:121], v[76:77], v[148:149]
  v_pk_fma_f32 v[146:147], v[126:127], v[78:79], v[146:147] neg_lo:[1,0,0] neg_hi:[1,0,0]
  v_pk_fma_f32 v[150:151], v[122:123], v[78:79], v[150:151]
  v_cvt_pk_bf16_f32 v8, v144, v148
  v_cvt_pk_bf16_f32 v9, v145, v149
  v_cvt_pk_bf16_f32 v10, v146, v150
  v_cvt_pk_bf16_f32 v11, v147, v151
  v_pk_mul_f32 v[144:145], v[128:129], v[72:73]
  v_pk_mul_f32 v[148:149], v[132:133], v[72:73]
  v_pk_mul_f32 v[146:147], v[130:131], v[74:75]
  v_pk_mul_f32 v[150:151], v[134:135], v[74:75]
  v_pk_fma_f32 v[144:145], v[132:133], v[76:77], v[144:145] neg_lo:[1,0,0] neg_hi:[1,0,0]
  v_pk_fma_f32 v[148:149], v[128:129], v[76:77], v[148:149]
  v_pk_fma_f32 v[146:147], v[134:135], v[78:79], v[146:147] neg_lo:[1,0,0] neg_hi:[1,0,0]
  v_pk_fma_f32 v[150:151], v[130:131], v[78:79], v[150:151]
  v_cvt_pk_bf16_f32 v12, v144, v148
  v_cvt_pk_bf16_f32 v13, v145, v149
  v_cvt_pk_bf16_f32 v14, v146, v150
  v_cvt_pk_bf16_f32 v15, v147, v151
  v_pk_mul_f32 v[144:145], v[136:137], v[72:73]
  v_pk_mul_f32 v[148:149], v[140:141], v[72:73]
  v_pk_mul_f32 v[146:147], v[138:139], v[74:75]
  v_pk_mul_f32 v[150:151], v[142:143], v[74:75]
  v_pk_fma_f32 v[144:145], v[140:141], v[76:77], v[144:145] neg_lo:[1,0,0] neg_hi:[1,0,0]
  v_pk_fma_f32 v[148:149], v[136:137], v[76:77], v[148:149]
  v_pk_fma_f32 v[146:147], v[142:143], v[78:79], v[146:147] neg_lo:[1,0,0] neg_hi:[1,0,0]
  v_pk_fma_f32 v[150:151], v[138:139], v[78:79], v[150:151]
  v_cvt_pk_bf16_f32 v16, v144, v148
  v_cvt_pk_bf16_f32 v17, v145, v149
  v_cvt_pk_bf16_f32 v18, v146, v150
  v_cvt_pk_bf16_f32 v19, v147, v151
  s_nop 1
  v_mfma_f32_16x16x32_bf16 v[112:115], v[64:67], v[4:7], 0
  v_mfma_f32_16x16x32_bf16 v[116:119], v[68:71], v[4:7], 0
  v_mfma_f32_16x16x32_bf16 v[120:123], v[64:67], v[8:11], 0
  v_mfma_f32_16x16x32_bf16 v[124:127], v[68:71], v[8:11], 0
  v_mfma_f32_16x16x32_bf16 v[128:131], v[64:67], v[12:15], 0
  v_mfma_f32_16x16x32_bf16 v[132:135], v[68:71], v[12:15], 0
  v_mfma_f32_16x16x32_bf16 v[136:139], v[64:67], v[16:19], 0
  v_mfma_f32_16x16x32_bf16 v[140:143], v[68:71], v[16:19], 0
  s_nop 7
  v_cvt_pk_bf16_f32 v96, v112, v113
  v_cvt_pk_bf16_f32 v97, v120, v121
  v_cvt_pk_bf16_f32 v98, v128, v129
  v_cvt_pk_bf16_f32 v99, v136, v137
  v_cvt_pk_bf16_f32 v100, v114, v115
  v_cvt_pk_bf16_f32 v101, v122, v123
  v_cvt_pk_bf16_f32 v102, v130, v131
  v_cvt_pk_bf16_f32 v103, v138, v139
  v_cvt_pk_bf16_f32 v104, v116, v117
  v_cvt_pk_bf16_f32 v105, v124, v125
  v_cvt_pk_bf16_f32 v106, v132, v133
  v_cvt_pk_bf16_f32 v107, v140, v141
  v_cvt_pk_bf16_f32 v108, v118, v119
  v_cvt_pk_bf16_f32 v109, v126, v127
  v_cvt_pk_bf16_f32 v110, v134, v135
  v_cvt_pk_bf16_f32 v111, v142, v143
  ds_write_b128 v33, v[96:99] offset:32768
  ds_write_b128 v33, v[100:103] offset:33792
  ds_write_b128 v33, v[104:107] offset:40960
  ds_write_b128 v33, v[108:111] offset:41984
  s_waitcnt lgkmcnt(0)
  s_barrier
  v_lshlrev_b32 v30, 4, v0
  v_add_u32 v30, s22, v30
  ds_read_b128 v[4:7], v30 offset:32768
  ds_read_b128 v[8:11], v30 offset:33792
  ds_read_b128 v[12:15], v30 offset:34816
  ds_read_b128 v[16:19], v30 offset:35840
  s_waitcnt lgkmcnt(3)
  buffer_store_dwordx4 v[4:7], v31, s[12:15], s23 offen offset:0 sc1
  s_waitcnt lgkmcnt(2)
  buffer_store_dwordx4 v[8:11], v31, s[12:15], s23 offen offset:1024 sc1
  s_waitcnt lgkmcnt(1)
  buffer_store_dwordx4 v[12:15], v31, s[12:15], s23 offen offset:2048 sc1
  s_waitcnt lgkmcnt(0)
  buffer_store_dwordx4 v[16:19], v31, s[12:15], s23 offen offset:3072 sc1
  s_branch p2end_28
p2nyq_29:
  s_and_b32 s22, s16, 1
  s_lshl_b32 s22, s22, 12
  s_add_u32 s23, s22, 4259840
  v_lshlrev_b32 v30, 4, v0
  s_cmp_lt_u32 s16, 6
  s_cbranch_scc1 nyd_30
  s_add_u32 m0, s22, 49152
  s_add_u32 s24, s23, 0
  buffer_load_dwordx4 v30, s[4:7], s24 offen sc1 lds
  s_add_u32 m0, s22, 50176
  s_add_u32 s24, s23, 1024
  buffer_load_dwordx4 v30, s[4:7], s24 offen sc1 lds
  s_add_u32 m0, s22, 51200
  s_add_u32 s24, s23, 2048
  buffer_load_dwordx4 v30, s[4:7], s24 offen sc1 lds
  s_add_u32 m0, s22, 52224
  s_add_u32 s24, s23, 3072
  buffer_load_dwordx4 v30, s[4:7], s24 offen sc1 lds
nyd_30:
  s_cmp_lg_u32 s16, 5
  s_cbranch_scc1 pw_32
  s_add_u32 s64, s30, 71335936
  s_addc_u32 s65, s31, 0
  s_mov_b32 s66, 32768
  s_mov_b32 s67, 0x20000
  s_bfe_u32 s3, s2, 0x30004
  s_lshl_b32 s3, s3, 12
  v_and_b32 v250, 15, v0
  v_lshlrev_b32 v250, 8, v250
  v_add_u32 v250, s3, v250
  s_mov_b32 s3, 0x20000
  buffer_load_dword v251, v250, s[64:67], 0 offen sc1
pl_33:
  s_waitcnt vmcnt(0)
  v_cmp_gt_u32 vcc, 16, v251
  s_sub_u32 s3, s3, 1
  s_cbranch_scc1 pd_34
  s_cmp_eq_u64 vcc, 0
  s_cbranch_scc1 pd_34
  s_sleep 1
  buffer_load_dword v251, v250, s[64:67], 0 offen sc1
  s_branch pl_33
pd_34:
pw_32:
  s_barrier
  s_cmp_lt_u32 s16, 6
  s_cbranch_scc1 nyd_31
  s_add_u32 m0, s22, 57344
  s_add_u32 s24, s23, 0
  buffer_load_dwordx4 v30, s[8:11], s24 offen sc1 lds
  s_add_u32 m0, s22, 58368
  s_add_u32 s24, s23, 1024
  buffer_load_dwordx4 v30, s[8:11], s24 offen sc1 lds
  s_add_u32 m0, s22, 59392
  s_add_u32 s24, s23, 2048
  buffer_load_dwordx4 v30, s[8:11], s24 offen sc1 lds
  s_add_u32 m0, s22, 60416
  s_add_u32 s24, s23, 3072
  buffer_load_dwordx4 v30, s[8:11], s24 offen sc1 lds
nyd_31:
  s_waitcnt vmcnt(4)
  s_barrier
  s_lshl_b32 s22, s20, 11
  s_add_u32 s23, s22, 4259840
  ds_read_b32 v4, v34 offset:0
  ds_read_b32 v5, v34 offset:512
  ds_read_b32 v6, v34 offset:1024
  ds_read_b32 v7, v34 offset:1536
  ds_read_b32 v8, v34 offset:4
  ds_read_b32 v9, v34 offset:516
  ds_read_b32 v10, v34 offset:1028
  ds_read_b32 v11, v34 offset:1540
  s_waitcnt lgkmcnt(0)
  s_nop 1
  v_mfma_f32_16x16x32_bf16 v[112:115], v[4:7], v[40:43], 0
  v_mfma_f32_16x16x32_bf16 v[116:119], v[4:7], v[44:47], 0
  v_mfma_f32_16x16x32_bf16 v[120:123], v[8:11], v[40:43], 0
  v_mfma_f32_16x16x32_bf16 v[124:127], v[8:11], v[44:47], 0
  s_nop 5
  v_pk_mul_f32 v[144:145], v[112:113], v[72:73]
  v_pk_mul_f32 v[148:149], v[116:117], v[72:73]
  v_pk_mul_f32 v[146:147], v[114:115], v[74:75]
  v_pk_mul_f32 v[150:151], v[118:119], v[74:75]
  v_pk_fma_f32 v[144:145], v[116:117], v[76:77], v[144:145]
  v_pk_fma_f32 v[148:149], v[112:113], v[76:77], v[148:149] neg_lo:[1,0,0] neg_hi:[1,0,0]
  v_pk_fma_f32 v[146:147], v[118:119], v[78:79], v[146:147]
  v_pk_fma_f32 v[150:151], v[114:115], v[78:79], v[150:151] neg_lo:[1,0,0] neg_hi:[1,0,0]
  v_cvt_pk_bf16_f32 v4, v144, v148
  v_cvt_pk_bf16_f32 v5, v145, v149
  v_cvt_pk_bf16_f32 v6, v146, v150
  v_cvt_pk_bf16_f32 v7, v147, v151
  v_pk_mul_f32 v[144:145], v[120:121], v[72:73]
  v_pk_mul_f32 v[148:149], v[124:125], v[72:73]
  v_pk_mul_f32 v[146:147], v[122:123], v[74:75]
  v_pk_mul_f32 v[150:151], v[126:127], v[74:75]
  v_pk_fma_f32 v[144:145], v[124:125], v[76:77], v[144:145]
  v_pk_fma_f32 v[148:149], v[120:121], v[76:77], v[148:149] neg_lo:[1,0,0] neg_hi:[1,0,0]
  v_pk_fma_f32 v[146:147], v[126:127], v[78:79], v[146:147]
  v_pk_fma_f32 v[150:151], v[122:123], v[78:79], v[150:151] neg_lo:[1,0,0] neg_hi:[1,0,0]
  v_cvt_pk_bf16_f32 v8, v144, v148
  v_cvt_pk_bf16_f32 v9, v145, v149
  v_cvt_pk_bf16_f32 v10, v146, v150
  v_cvt_pk_bf16_f32 v11, v147, v151
  s_nop 1
  v_mfma_f32_16x16x32_bf16 v[112:115], v[48:51], v[4:7], 0
  v_mfma_f32_16x16x32_bf16 v[116:119], v[52:55], v[4:7], 0
  v_mfma_f32_16x16x32_bf16 v[120:123], v[48:51], v[8:11], 0
  v_mfma_f32_16x16x32_bf16 v[124:127], v[52:55], v[8:11], 0
  s_mov_b32 s26, 0xffff0000
  s_waitcnt vmcnt(0)
  s_barrier
  ds_read_b32 v96, v35 offset:8192
  ds_read_b32 v97, v35 offset:8196
  ds_read_b32 v98, v35 offset:8704
  ds_read_b32 v99, v35 offset:8708
  ds_read_b32 v100, v35 offset:12288
  ds_read_b32 v101, v35 offset:12292
  ds_read_b32 v102, v35 offset:12800
  ds_read_b32 v103, v35 offset:12804
  s_waitcnt lgkmcnt(0)
  s_nop 4
  v_lshlrev_b32 v144, 16, v96
  v_and_b32 v145, s26, v96
  v_pk_mul_f32 v[146:147], v[112:113], v[144:145] op_sel:[0,0] op_sel_hi:[1,0]
  v_pk_fma_f32 v[146:147], v[112:113], v[144:145], v[146:147] op_sel:[1,1,0] op_sel_hi:[0,1,1] neg_lo:[1,0,0]
  v_cvt_pk_bf16_f32 v4, v146, v147
  v_lshlrev_b32 v144, 16, v98
  v_and_b32 v145, s26, v98
  v_pk_mul_f32 v[146:147], v[114:115], v[144:145] op_sel:[0,0] op_sel_hi:[1,0]
  v_pk_fma_f32 v[146:147], v[114:115], v[144:145], v[146:147] op_sel:[1,1,0] op_sel_hi:[0,1,1] neg_lo:[1,0,0]
  v_cvt_pk_bf16_f32 v5, v146, v147
  v_lshlrev_b32 v144, 16, v100
  v_and_b32 v145, s26, v100
  v_pk_mul_f32 v[146:147], v[116:117], v[144:145] op_sel:[0,0] op_sel_hi:[1,0]
  v_pk_fma_f32 v[146:147], v[116:117], v[144:145], v[146:147] op_sel:[1,1,0] op_sel_hi:[0,1,1] neg_lo:[1,0,0]
  v_cvt_pk_bf16_f32 v6, v146, v147
  v_lshlrev_b32 v144, 16, v102
  v_and_b32 v145, s26, v102
  v_pk_mul_f32 v[146:147], v[118:119], v[144:145] op_sel:[0,0] op_sel_hi:[1,0]
  v_pk_fma_f32 v[146:147], v[118:119], v[144:145], v[146:147] op_sel:[1,1,0] op_sel_hi:[0,1,1] neg_lo:[1,0,0]
  v_cvt_pk_bf16_f32 v7, v146, v147
  v_lshlrev_b32 v144, 16, v97
  v_and_b32 v145, s26, v97
  v_pk_mul_f32 v[146:147], v[120:121], v[144:145] op_sel:[0,0] op_sel_hi:[1,0]
  v_pk_fma_f32 v[146:147], v[120:121], v[144:145], v[146:147] op_sel:[1,1,0] op_sel_hi:[0,1,1] neg_lo:[1,0,0]
  v_cvt_pk_bf16_f32 v8, v146, v147
  v_lshlrev_b32 v144, 16, v99
  v_and_b32 v145, s26, v99
  v_pk_mul_f32 v[146:147], v[122:123], v[144:145] op_sel:[0,0] op_sel_hi:[1,0]
  v_pk_fma_f32 v[146:147], v[122:123], v[144:145], v[146:147] op_sel:[1,1,0] op_sel_hi:[0,1,1] neg_lo:[1,0,0]
  v_cvt_pk_bf16_f32 v9, v146, v147
  v_lshlrev_b32 v144, 16, v101
  v_and_b32 v145, s26, v101
  v_pk_mul_f32 v[146:147], v[124:125], v[144:145] op_sel:[0,0] op_sel_hi:[1,0]
  v_pk_fma_f32 v[146:147], v[124:125], v[144:145], v[146:147] op_sel:[1,1,0] op_sel_hi:[0,1,1] neg_lo:[1,0,0]
  v_cvt_pk_bf16_f32 v10, v146, v147
  v_lshlrev_b32 v144, 16, v103
  v_and_b32 v145, s26, v103
  v_pk_mul_f32 v[146:147], v[126:127], v[144:145] op_sel:[0,0] op_sel_hi:[1,0]
  v_pk_fma_f32 v[146:147], v[126:127], v[144:145], v[146:147] op_sel:[1,1,0] op_sel_hi:[0,1,1] neg_lo:[1,0,0]
  v_cvt_pk_bf16_f32 v11, v146, v147
  s_nop 1
  v_mfma_f32_16x16x32_bf16 v[112:115], v[4:7], v[56:59], 0
  v_mfma_f32_16x16x32_bf16 v[116:119], v[4:7], v[60:63], 0
  v_mfma_f32_16x16x32_bf16 v[120:123], v[8:11], v[56:59], 0
  v_mfma_f32_16x16x32_bf16 v[124:127], v[8:11], v[60:63], 0
  s_nop 5
  v_pk_mul_f32 v[144:145], v[112:113], v[72:73]
  v_pk_mul_f32 v[148:149], v[116:117], v[72:73]
  v_pk_mul_f32 v[146:147], v[114:115], v[74:75]
  v_pk_mul_f32 v[150:151], v[118:119], v[74:75]
  v_pk_fma_f32 v[144:145], v[116:117], v[76:77], v[144:145] neg_lo:[1,0,0] neg_hi:[1,0,0]
  v_pk_fma_f32 v[148:149], v[112:113], v[76:77], v[148:149]
  v_pk_fma_f32 v[146:147], v[118:119], v[78:79], v[146:147] neg_lo:[1,0,0] neg_hi:[1,0,0]
  v_pk_fma_f32 v[150:151], v[114:115], v[78:79], v[150:151]
  v_cvt_pk_bf16_f32 v4, v144, v148
  v_cvt_pk_bf16_f32 v5, v145, v149
  v_cvt_pk_bf16_f32 v6, v146, v150
  v_cvt_pk_bf16_f32 v7, v147, v151
  v_pk_mul_f32 v[144:145], v[120:121], v[72:73]
  v_pk_mul_f32 v[148:149], v[124:125], v[72:73]
  v_pk_mul_f32 v[146:147], v[122:123], v[74:75]
  v_pk_mul_f32 v[150:151], v[126:127], v[74:75]
  v_pk_fma_f32 v[144:145], v[124:125], v[76:77], v[144:145] neg_lo:[1,0,0] neg_hi:[1,0,0]
  v_pk_fma_f32 v[148:149], v[120:121], v[76:77], v[148:149]
  v_pk_fma_f32 v[146:147], v[126:127], v[78:79], v[146:147] neg_lo:[1,0,0] neg_hi:[1,0,0]
  v_pk_fma_f32 v[150:151], v[122:123], v[78:79], v[150:151]
  v_cvt_pk_bf16_f32 v8, v144, v148
  v_cvt_pk_bf16_f32 v9, v145, v149
  v_cvt_pk_bf16_f32 v10, v146, v150
  v_cvt_pk_bf16_f32 v11, v147, v151
  s_nop 1
  v_mfma_f32_16x16x32_bf16 v[112:115], v[64:67], v[4:7], 0
  v_mfma_f32_16x16x32_bf16 v[116:119], v[68:71], v[4:7], 0
  v_mfma_f32_16x16x32_bf16 v[120:123], v[64:67], v[8:11], 0
  v_mfma_f32_16x16x32_bf16 v[124:127], v[68:71], v[8:11], 0
  s_nop 7
  v_cvt_pk_bf16_f32 v96, v112, v113
  v_cvt_pk_bf16_f32 v97, v120, v121
  v_cvt_pk_bf16_f32 v98, v114, v115
  v_cvt_pk_bf16_f32 v99, v122, v123
  v_cvt_pk_bf16_f32 v100, v116, v117
  v_cvt_pk_bf16_f32 v101, v124, v125
  v_cvt_pk_bf16_f32 v102, v118, v119
  v_cvt_pk_bf16_f32 v103, v126, v127
  ds_write_b64 v35, v[96:97] offset:16384
  ds_write_b64 v35, v[98:99] offset:16896
  ds_write_b64 v35, v[100:101] offset:20480
  ds_write_b64 v35, v[102:103] offset:20992
  s_waitcnt lgkmcnt(0)
  s_barrier
  s_add_u32 s24, s22, 65536
  v_add_u32 v29, s24, v30
  ds_read_b128 v[4:7], v29 offset:0
  ds_read_b128 v[8:11], v29 offset:1024
  s_waitcnt lgkmcnt(1)
  buffer_store_dwordx4 v[4:7], v30, s[12:15], s23 offen offset:0 sc1
  s_waitcnt lgkmcnt(0)
  buffer_store_dwordx4 v[8:11], v30, s[12:15], s23 offen offset:1024 sc1
  s_branch p2end_28
p2idle_27:
  s_cmp_lg_u32 s16, 5
  s_cbranch_scc1 pw_35
  s_add_u32 s64, s30, 71335936
  s_addc_u32 s65, s31, 0
  s_mov_b32 s66, 32768
  s_mov_b32 s67, 0x20000
  s_bfe_u32 s3, s2, 0x30004
  s_lshl_b32 s3, s3, 12
  v_and_b32 v250, 15, v0
  v_lshlrev_b32 v250, 8, v250
  v_add_u32 v250, s3, v250
  s_mov_b32 s3, 0x20000
  buffer_load_dword v251, v250, s[64:67], 0 offen sc1
pl_36:
  s_waitcnt vmcnt(0)
  v_cmp_gt_u32 vcc, 16, v251
  s_sub_u32 s3, s3, 1
  s_cbranch_scc1 pd_37
  s_cmp_eq_u64 vcc, 0
  s_cbranch_scc1 pd_37
  s_sleep 1
  buffer_load_dword v251, v250, s[64:67], 0 offen sc1
  s_branch pl_36
pd_37:
pw_35:
  s_barrier
  s_barrier
  s_barrier
  s_barrier
p2end_28:
  s_cmp_eq_u32 s19, 0
  s_cbranch_scc1 nw_38
  s_waitcnt vmcnt(0)
nw_38:
  s_waitcnt lgkmcnt(0)
  s_barrier
  s_cmp_lg_u32 s16, 0
  s_cbranch_scc1 arr_39
  s_add_u32 s64, s30, 71368704
  s_addc_u32 s65, s31, 0
  s_mov_b32 s66, 32768
  s_mov_b32 s67, 0x20000
  s_and_b32 s3, s2, 15
  s_lshl_b32 s3, s3, 8
  v_lshlrev_b32 v250, 12, v0
  v_add_u32 v250, s3, v250
  v_mov_b32 v251, 1
  s_mov_b64 exec, 0xff
  buffer_atomic_add v251, v250, s[64:67], 0 offen sc1
  s_mov_b64 exec, -1
arr_39:
  s_mov_b32 s56, s88
  s_mov_b32 s57, s89
  s_mov_b32 s58, 7340032
  s_mov_b32 s59, 0x20000
  s_and_b32 s54, s16, 3
  v_lshl_add_u32 v222, s54, 6, v0
  v_lshlrev_b32 v222, 4, v222
  s_cmp_lt_u32 s16, 4
  s_cbranch_scc1 pfp_40
  s_mul_i32 s54, s2, 12288
  s_add_u32 s54, s54, 0
  buffer_load_dwordx4 v[224:227], v222, s[56:59], s54 offen
  s_mul_i32 s54, s2, 12288
  s_add_u32 s54, s54, 4096
  buffer_load_dwordx4 v[224:227], v222, s[56:59], s54 offen
  s_mul_i32 s54, s2, 12288
  s_add_u32 s54, s54, 8192
  buffer_load_dwordx4 v[224:227], v222, s[56:59], s54 offen
pfp_40:
  s_and_b32 s17, s2, 7
  s_lshl_b32 s17, s17, 1
  s_bfe_u32 s3, s2, 0x10003
  s_or_b32 s17, s17, s3
  s_and_b32 s3, s2, 0xf0
  s_or_b32 s17, s17, s3
  s_mov_b32 s4, s80
  s_mov_b32 s5, s81
  s_mov_b32 s6, 4194304
  s_mov_b32 s7, 0x20000
  s_add_u32 s8, s30, 16777216
  s_addc_u32 s9, s31, 0
  s_mov_b32 s10, 4276480
  s_mov_b32 s11, 0x20000
  s_add_u32 s12, s30, 25165824
  s_addc_u32 s13, s31, 0
  s_mov_b32 s14, 4194304
  s_mov_b32 s15, 0x20000
  s_add_u32 s48, s30, 33554432
  s_addc_u32 s49, s31, 0
  s_mov_b32 s50, 4194304
  s_mov_b32 s51, 0x20000
  v_and_b32 v3, 31, v0
  v_lshlrev_b32 v3, 6, v3
  v_lshrrev_b32 v40, 5, v0
  v_lshl_add_u32 v3, v40, 3, v3
  s_lshl_b32 s18, s16, 8
  s_add_u32 s18, s18, s17
  s_lshl_b32 s18, s18, 11
  buffer_load_dwordx2 v[24:25], v3, s[4:7], s18 offen offset:0
  buffer_load_dwordx2 v[26:27], v3, s[4:7], s18 offen offset:16
  buffer_load_dwordx2 v[28:29], v3, s[4:7], s18 offen offset:32
  buffer_load_dwordx2 v[30:31], v3, s[4:7], s18 offen offset:48
  v_lshlrev_b32 v92, 4, v0
  v_add_u32 v92, 98304, v92
  ds_read_b128 v[40:43], v92 offset:27648
  ds_read_b128 v[44:47], v92 offset:28672
  ds_read_b128 v[48:51], v92 offset:29696
  ds_read_b128 v[52:55], v92 offset:30720
  ds_read_b128 v[56:59], v92 offset:31744
  ds_read_b128 v[104:107], v92 offset:32768
  ds_read_b128 v[108:111], v92 offset:33792
  ds_read_b128 v[112:115], v92 offset:34816
  ds_read_b128 v[116:119], v92 offset:35840
  ds_read_b128 v[60:63], v92 offset:4096
  ds_read_b128 v[64:67], v92 offset:5120
  ds_read_b128 v[68:71], v92 offset:6144
  s_waitcnt lgkmcnt(4)
  ds_read_b128 v[72:75], v92 offset:7168
  ds_read_b128 v[76:79], v92 offset:8192
  ds_read_b128 v[80:83], v92 offset:9216
  ds_read_b128 v[84:87], v92 offset:10240
  ds_read_b128 v[88:91], v92 offset:11264
  v_bfe_u32 v96, v0, 1, 4
  s_mov_b32 s22, 16640
  v_mul_lo_u32 v2, v96, s22
  v_and_b32 v96, 1, v0
  v_lshl_add_u32 v2, v96, 5, v2
  v_lshrrev_b32 v96, 5, v0
  v_lshl_add_u32 v2, v96, 4, v2
  v_lshlrev_b32 v23, 4, v96
  s_mul_i32 s22, s16, 532480
  s_lshl_b32 s23, s17, 6
  s_add_u32 s22, s22, s23
  v_lshrrev_b32 v96, 5, v0
  v_lshlrev_b32 v192, 13, v96
  v_and_b32 v96, 31, v0
  v_lshl_add_u32 v192, v96, 6, v192
  s_lshr_b32 s24, s16, 1
  v_bfe_u32 v96, v0, 2, 2
  v_xor_b32 v96, s24, v96
  v_lshl_add_u32 v192, v96, 4, v192
  s_and_b32 s24, s16, 1
  s_lshl_b32 s24, s24, 3
  s_add_u32 s24, s24, 139264
  v_add_u32 v192, s24, v192
  v_and_b32 v98, 31, v0
  v_lshlrev_b32 v193, 6, v98
  s_lshl_b32 s24, s16, 11
  s_add_u32 s24, s24, 139264
  v_add_u32 v193, s24, v193
  v_lshrrev_b32 v98, 5, v0
  v_bfe_u32 v99, v0, 2, 2
  v_xor_b32 v98, v98, v99
  v_xor_b32 v99, 2, v98
  v_lshl_add_u32 v194, v99, 4, v193
  v_lshl_add_u32 v193, v98, 4, v193
  s_lshl_b32 s25, s16, 2
  s_add_u32 s25, s25, 155648
  v_mov_b32 v195, s25
  v_add_u32 v203, 155648, v23
  v_and_b32 v196, 1, v0
  v_cvt_f32_u32 v196, v196
  v_fma_f32 v196, v196, -2.0, 1.0
  v_cmp_gt_u32 vcc, 32, v0
  s_nop 1
  v_cndmask_b32 v196, 0, v196, vcc
  v_and_b32 v96, 31, v0
  v_lshlrev_b32 v97, 6, v96
  v_lshrrev_b32 v98, 5, v0
  v_lshl_add_u32 v97, v98, 3, v97
  v_add_u32 v97, s24, v97
  v_bfe_u32 v96, v0, 1, 2
  v_xor_b32 v98, 0, v96
  v_lshl_add_u32 v197, v98, 4, v97
  v_xor_b32 v98, 1, v96
  v_lshl_add_u32 v198, v98, 4, v97
  v_xor_b32 v98, 2, v96
  v_lshl_add_u32 v199, v98, 4, v97
  v_xor_b32 v98, 3, v96
  v_lshl_add_u32 v200, v98, 4, v97
  v_lshrrev_b32 v96, 2, v0
  v_lshlrev_b32 v201, 6, v96
  v_bfe_u32 v96, v0, 3, 2
  v_and_b32 v97, 3, v0
  v_xor_b32 v96, v96, v97
  v_lshl_add_u32 v201, v96, 4, v201
  v_add_u32 v201, s24, v201
  v_lshlrev_b32 v202, 4, v0
  s_lshr_b32 s25, s18, 11
  s_mul_i32 s25, s25, 2048
  s_mov_b32 s26, 0xffff0000
  s_mov_b32 s44, 0x35800000
  s_mov_b32 s45, 0x35800000
  s_waitcnt lgkmcnt(0)
  s_cmp_lg_u32 s16, 0
  s_cbranch_scc1 pw_41
  s_add_u32 s64, s30, 71368704
  s_addc_u32 s65, s31, 0
  s_mov_b32 s66, 32768
  s_mov_b32 s67, 0x20000
  s_bfe_u32 s3, s2, 0x30004
  s_lshl_b32 s3, s3, 12
  v_and_b32 v250, 15, v0
  v_lshlrev_b32 v250, 8, v250
  v_add_u32 v250, s3, v250
  s_mov_b32 s3, 0x20000
  buffer_load_dword v251, v250, s[64:67], 0 offen sc1
pl_42:
  s_waitcnt vmcnt(0)
  v_cmp_gt_u32 vcc, 16, v251
  s_sub_u32 s3, s3, 1
  s_cbranch_scc1 pd_43
  s_cmp_eq_u64 vcc, 0
  s_cbranch_scc1 pd_43
  s_sleep 1
  buffer_load_dword v251, v250, s[64:67], 0 offen sc1
  s_branch pl_42
pd_43:
pw_41:
  s_barrier
  buffer_load_dwordx4 v[4:7], v2, s[8:11], s22 offen sc1
  s_add_u32 s22, s22, 266240
  buffer_load_dwordx4 v[8:11], v2, s[8:11], s22 offen sc1
  s_add_u32 s22, s22, 266240
  s_lshl_b32 s22, s17, 5
  s_add_u32 s22, s22, 4259840
  buffer_load_dwordx4 v[12:15], v23, s[8:11], s22 offen sc1
  s_waitcnt vmcnt(2)
  v_mfma_f32_32x32x16_bf16 v[144:159], v[40:43], v[4:7], 0
  s_waitcnt vmcnt(1)
  v_mfma_f32_32x32x16_bf16 v[160:175], v[40:43], v[8:11], 0
  s_waitcnt vmcnt(0)
  v_mfma_f32_32x32x16_bf16 v[176:191], v[40:43], v[12:15], 0
  s_mov_b32 s56, s88
  s_mov_b32 s57, s89
  s_mov_b32 s58, 7340032
  s_mov_b32 s59, 0x20000
  s_and_b32 s54, s16, 3
  v_lshl_add_u32 v222, s54, 6, v0
  v_lshlrev_b32 v222, 4, v222
  s_cmp_lt_u32 s16, 4
  s_cbranch_scc1 pfp_44
  s_mul_i32 s54, s2, 16384
  s_add_u32 s54, s54, 3145728
  buffer_load_dwordx4 v[224:227], v222, s[56:59], s54 offen
  s_mul_i32 s54, s2, 16384
  s_add_u32 s54, s54, 3149824
  buffer_load_dwordx4 v[224:227], v222, s[56:59], s54 offen
  s_mul_i32 s54, s2, 16384
  s_add_u32 s54, s54, 3153920
  buffer_load_dwordx4 v[224:227], v222, s[56:59], s54 offen
  s_mul_i32 s54, s2, 16384
  s_add_u32 s54, s54, 3158016
  buffer_load_dwordx4 v[224:227], v222, s[56:59], s54 offen
pfp_44:
  s_nop 11
  v_cvt_pk_bf16_f32 v120, v144, v145
  v_cvt_pk_bf16_f32 v121, v146, v147
  v_cvt_pk_bf16_f32 v122, v148, v149
  v_cvt_pk_bf16_f32 v123, v150, v151
  v_cvt_pk_bf16_f32 v124, v160, v161
  v_cvt_pk_bf16_f32 v125, v162, v163
  v_cvt_pk_bf16_f32 v126, v164, v165
  v_cvt_pk_bf16_f32 v127, v166, v167
  s_cmp_lg_u32 s16, 0
  s_cbranch_scc1 p3dc_45
  s_mov_b32 exec_lo, 1
  s_mov_b32 exec_hi, 1
  v_mul_f32 v96, 0.5, v144
  v_cvt_pk_bf16_f32 v120, v96, 0
  v_mul_f32 v96, 0.5, v146
  v_cvt_pk_bf16_f32 v121, v96, 0
  v_mul_f32 v96, 0.5, v148
  v_cvt_pk_bf16_f32 v122, v96, 0
  v_mul_f32 v96, 0.5, v150
  v_cvt_pk_bf16_f32 v123, v96, 0
  s_mov_b64 exec, -1
p3dc_45:
  s_cmp_lg_u32 s16, 7
  s_cbranch_scc1 p3ny_46
  v_mul_f32 v98, 0.5, v176
  v_mul_f32 v99, 0.5, v178
  v_mul_f32 v100, 0.5, v180
  v_mul_f32 v101, 0.5, v182
  s_mov_b32 exec_lo, 1
  s_mov_b32 exec_hi, 1
  ds_write_b128 v203, v[98:101]
  s_mov_b64 exec, -1
p3ny_46:
  ds_write_b32 v192, v120 offset:0
  ds_write_b32 v192, v121 offset:2048
  ds_write_b32 v192, v122 offset:4096
  ds_write_b32 v192, v123 offset:6144
  ds_write_b32 v192, v124 offset:4
  ds_write_b32 v192, v125 offset:2052
  ds_write_b32 v192, v126 offset:4100
  ds_write_b32 v192, v127 offset:6148
  s_waitcnt lgkmcnt(0)
  s_barrier
  ds_read_b128 v[120:123], v193
  ds_read_b128 v[124:127], v194
  ds_read_b32 v136, v195
  s_waitcnt lgkmcnt(2)
  v_mfma_f32_32x32x16_bf16 v[144:159], v[120:123], v[44:47], 0
  v_mfma_f32_32x32x16_bf16 v[160:175], v[120:123], v[52:55], 0
  s_waitcnt lgkmcnt(1)
  v_mfma_f32_32x32x16_bf16 v[144:159], v[124:127], v[48:51], v[144:159]
  v_mfma_f32_32x32x16_bf16 v[160:175], v[124:127], v[56:59], v[160:175]
  s_waitcnt lgkmcnt(0)
  s_nop 10
  v_fma_f32 v144, v196, v136, v144
  v_pk_mul_f32 v[208:209], v[144:145], v[60:61]
  v_pk_mul_f32 v[210:211], v[160:161], v[60:61]
  v_pk_fma_f32 v[208:209], v[160:161], v[76:77], v[208:209] neg_lo:[1,0,0] neg_hi:[1,0,0]
  v_pk_fma_f32 v[210:211], v[144:145], v[76:77], v[210:211]
  v_cvt_pk_bf16_f32 v4, v208, v209
  v_cvt_pk_bf16_f32 v12, v210, v211
  v_pk_mul_f32 v[208:209], v[146:147], v[62:63]
  v_pk_mul_f32 v[210:211], v[162:163], v[62:63]
  v_pk_fma_f32 v[208:209], v[162:163], v[78:79], v[208:209] neg_lo:[1,0,0] neg_hi:[1,0,0]
  v_pk_fma_f32 v[210:211], v[146:147], v[78:79], v[210:211]
  v_cvt_pk_bf16_f32 v5, v208, v209
  v_cvt_pk_bf16_f32 v13, v210, v211
  v_pk_mul_f32 v[208:209], v[148:149], v[64:65]
  v_pk_mul_f32 v[210:211], v[164:165], v[64:65]
  v_pk_fma_f32 v[208:209], v[164:165], v[80:81], v[208:209] neg_lo:[1,0,0] neg_hi:[1,0,0]
  v_pk_fma_f32 v[210:211], v[148:149], v[80:81], v[210:211]
  v_cvt_pk_bf16_f32 v6, v208, v209
  v_cvt_pk_bf16_f32 v14, v210, v211
  v_pk_mul_f32 v[208:209], v[150:151], v[66:67]
  v_pk_mul_f32 v[210:211], v[166:167], v[66:67]
  v_pk_fma_f32 v[208:209], v[166:167], v[82:83], v[208:209] neg_lo:[1,0,0] neg_hi:[1,0,0]
  v_pk_fma_f32 v[210:211], v[150:151], v[82:83], v[210:211]
  v_cvt_pk_bf16_f32 v7, v208, v209
  v_cvt_pk_bf16_f32 v15, v210, v211
  v_pk_mul_f32 v[208:209], v[152:153], v[68:69]
  v_pk_mul_f32 v[210:211], v[168:169], v[68:69]
  v_pk_fma_f32 v[208:209], v[168:169], v[84:85], v[208:209] neg_lo:[1,0,0] neg_hi:[1,0,0]
  v_pk_fma_f32 v[210:211], v[152:153], v[84:85], v[210:211]
  v_cvt_pk_bf16_f32 v8, v208, v209
  v_cvt_pk_bf16_f32 v16, v210, v211
  v_pk_mul_f32 v[208:209], v[154:155], v[70:71]
  v_pk_mul_f32 v[210:211], v[170:171], v[70:71]
  v_pk_fma_f32 v[208:209], v[170:171], v[86:87], v[208:209] neg_lo:[1,0,0] neg_hi:[1,0,0]
  v_pk_fma_f32 v[210:211], v[154:155], v[86:87], v[210:211]
  v_cvt_pk_bf16_f32 v9, v208, v209
  v_cvt_pk_bf16_f32 v17, v210, v211
  v_pk_mul_f32 v[208:209], v[156:157], v[72:73]
  v_pk_mul_f32 v[210:211], v[172:173], v[72:73]
  v_pk_fma_f32 v[208:209], v[172:173], v[88:89], v[208:209] neg_lo:[1,0,0] neg_hi:[1,0,0]
  v_pk_fma_f32 v[210:211], v[156:157], v[88:89], v[210:211]
  v_cvt_pk_bf16_f32 v10, v208, v209
  v_cvt_pk_bf16_f32 v18, v210, v211
  v_pk_mul_f32 v[208:209], v[158:159], v[74:75]
  v_pk_mul_f32 v[210:211], v[174:175], v[74:75]
  v_pk_fma_f32 v[208:209], v[174:175], v[90:91], v[208:209] neg_lo:[1,0,0] neg_hi:[1,0,0]
  v_pk_fma_f32 v[210:211], v[158:159], v[90:91], v[210:211]
  v_cvt_pk_bf16_f32 v11, v208, v209
  v_cvt_pk_bf16_f32 v19, v210, v211
  s_nop 1
  v_mfma_f32_32x32x16_bf16 v[144:159], v[4:7], v[104:107], 0
  v_mfma_f32_32x32x16_bf16 v[144:159], v[8:11], v[108:111], v[144:159]
  v_mfma_f32_32x32x16_bf16 v[144:159], v[12:15], v[112:115], v[144:159]
  v_mfma_f32_32x32x16_bf16 v[144:159], v[16:19], v[116:119], v[144:159]
  v_lshlrev_b32 v160, 16, v24
  v_and_b32 v161, s26, v24
  v_lshlrev_b32 v162, 16, v25
  v_and_b32 v163, s26, v25
  v_lshlrev_b32 v164, 16, v26
  v_and_b32 v165, s26, v26
  v_lshlrev_b32 v166, 16, v27
  v_and_b32 v167, s26, v27
  v_lshlrev_b32 v168, 16, v28
  v_and_b32 v169, s26, v28
  v_lshlrev_b32 v170, 16, v29
  v_and_b32 v171, s26, v29
  v_lshlrev_b32 v172, 16, v30
  v_and_b32 v173, s26, v30
  v_lshlrev_b32 v174, 16, v31
  v_and_b32 v175, s26, v31
  v_pk_mul_f32 v[144:145], v[144:145], s[44:45]
  v_cvt_pk_bf16_f32 v208, v144, v145
  v_lshlrev_b32 v144, 16, v208
  v_and_b32 v145, s26, v208
  v_pk_add_f32 v[160:161], v[160:161], v[144:145]
  v_cvt_pk_bf16_f32 v4, v160, v161
  v_lshlrev_b32 v160, 16, v4
  v_and_b32 v161, s26, v4
  v_pk_mul_f32 v[146:147], v[146:147], s[44:45]
  v_cvt_pk_bf16_f32 v208, v146, v147
  v_lshlrev_b32 v146, 16, v208
  v_and_b32 v147, s26, v208
  v_pk_add_f32 v[162:163], v[162:163], v[146:147]
  v_cvt_pk_bf16_f32 v5, v162, v163
  v_lshlrev_b32 v162, 16, v5
  v_and_b32 v163, s26, v5
  v_pk_mul_f32 v[148:149], v[148:149], s[44:45]
  v_cvt_pk_bf16_f32 v208, v148, v149
  v_lshlrev_b32 v148, 16, v208
  v_and_b32 v149, s26, v208
  v_pk_add_f32 v[164:165], v[164:165], v[148:149]
  v_cvt_pk_bf16_f32 v6, v164, v165
  v_lshlrev_b32 v164, 16, v6
  v_and_b32 v165, s26, v6
  v_pk_mul_f32 v[150:151], v[150:151], s[44:45]
  v_cvt_pk_bf16_f32 v208, v150, v151
  v_lshlrev_b32 v150, 16, v208
  v_and_b32 v151, s26, v208
  v_pk_add_f32 v[166:167], v[166:167], v[150:151]
  v_cvt_pk_bf16_f32 v7, v166, v167
  v_lshlrev_b32 v166, 16, v7
  v_and_b32 v167, s26, v7
  v_pk_mul_f32 v[152:153], v[152:153], s[44:45]
  v_cvt_pk_bf16_f32 v208, v152, v153
  v_lshlrev_b32 v152, 16, v208
  v_and_b32 v153, s26, v208
  v_pk_add_f32 v[168:169], v[168:169], v[152:153]
  v_cvt_pk_bf16_f32 v8, v168, v169
  v_lshlrev_b32 v168, 16, v8
  v_and_b32 v169, s26, v8
  v_pk_mul_f32 v[154:155], v[154:155], s[44:45]
  v_cvt_pk_bf16_f32 v208, v154, v155
  v_lshlrev_b32 v154, 16, v208
  v_and_b32 v155, s26, v208
  v_pk_add_f32 v[170:171], v[170:171], v[154:155]
  v_cvt_pk_bf16_f32 v9, v170, v171
  v_lshlrev_b32 v170, 16, v9
  v_and_b32 v171, s26, v9
  v_pk_mul_f32 v[156:157], v[156:157], s[44:45]
  v_cvt_pk_bf16_f32 v208, v156, v157
  v_lshlrev_b32 v156, 16, v208
  v_and_b32 v157, s26, v208
  v_pk_add_f32 v[172:173], v[172:173], v[156:157]
  v_cvt_pk_bf16_f32 v10, v172, v173
  v_lshlrev_b32 v172, 16, v10
  v_and_b32 v173, s26, v10
  v_pk_mul_f32 v[158:159], v[158:159], s[44:45]
  v_cvt_pk_bf16_f32 v208, v158, v159
  v_lshlrev_b32 v158, 16, v208
  v_and_b32 v159, s26, v208
  v_pk_add_f32 v[174:175], v[174:175], v[158:159]
  v_cvt_pk_bf16_f32 v11, v174, v175
  v_lshlrev_b32 v174, 16, v11
  v_and_b32 v175, s26, v11
  v_pk_add_f32 v[124:125], v[160:161], v[162:163]
  v_pk_mul_f32 v[126:127], v[160:161], v[160:161]
  v_pk_fma_f32 v[126:127], v[162:163], v[162:163], v[126:127]
  v_pk_add_f32 v[124:125], v[124:125], v[164:165]
  v_pk_fma_f32 v[126:127], v[164:165], v[164:165], v[126:127]
  v_pk_add_f32 v[124:125], v[124:125], v[166:167]
  v_pk_fma_f32 v[126:127], v[166:167], v[166:167], v[126:127]
  v_pk_add_f32 v[124:125], v[124:125], v[168:169]
  v_pk_fma_f32 v[126:127], v[168:169], v[168:169], v[126:127]
  v_pk_add_f32 v[124:125], v[124:125], v[170:171]
  v_pk_fma_f32 v[126:127], v[170:171], v[170:171], v[126:127]
  v_pk_add_f32 v[124:125], v[124:125], v[172:173]
  v_pk_fma_f32 v[126:127], v[172:173], v[172:173], v[126:127]
  v_pk_add_f32 v[124:125], v[124:125], v[174:175]
  v_pk_fma_f32 v[126:127], v[174:175], v[174:175], v[126:127]
  v_add_f32 v120, v124, v125
  v_add_f32 v121, v126, v127
  s_nop 1
  v_add_f32_dpp v120, v120, v120 row_ror:8 row_mask:0xf bank_mask:0xf
  v_add_f32_dpp v121, v121, v121 row_ror:8 row_mask:0xf bank_mask:0xf
  s_nop 1
  v_add_f32_dpp v120, v120, v120 row_ror:4 row_mask:0xf bank_mask:0xf
  v_add_f32_dpp v121, v121, v121 row_ror:4 row_mask:0xf bank_mask:0xf
  s_nop 1
  v_add_f32_dpp v120, v120, v120 row_ror:2 row_mask:0xf bank_mask:0xf
  v_add_f32_dpp v121, v121, v121 row_ror:2 row_mask:0xf bank_mask:0xf
  s_nop 1
  v_add_f32_dpp v120, v120, v120 row_ror:1 row_mask:0xf bank_mask:0xf
  v_add_f32_dpp v121, v121, v121 row_ror:1 row_mask:0xf bank_mask:0xf
  s_nop 1
  v_mov_b32 v132, v120
  v_mov_b32 v133, v121
  s_nop 1
  v_permlane16_swap_b32 v120, v132
  v_permlane16_swap_b32 v121, v133
  v_add_f32 v120, v120, v132
  v_add_f32 v121, v121, v133
  v_mov_b32 v132, v120
  v_mov_b32 v133, v121
  s_nop 1
  v_permlane32_swap_b32 v120, v132
  v_permlane32_swap_b32 v121, v133
  v_add_f32 v120, v120, v132
  v_add_f32 v121, v121, v133
  v_mul_f32 v120, 0x3a800000, v120
  v_mul_f32 v121, 0x3a800000, v121
  v_fma_f32 v121, -v120, v120, v121
  v_max_f32 v121, 0, v121
  v_cvt_pk_bf16_f32 v120, v120, v120
  v_lshlrev_b32 v120, 16, v120
  v_cvt_pk_bf16_f32 v121, v121, v121
  v_lshlrev_b32 v121, 16, v121
  v_add_f32 v121, 0x3727c5ac, v121
  v_cvt_pk_bf16_f32 v121, v121, v121
  v_lshlrev_b32 v121, 16, v121
  v_sqrt_f32 v121, v121
  s_nop 0
  v_cvt_pk_bf16_f32 v121, v121, v121
  v_lshlrev_b32 v121, 16, v121
  v_rcp_f32 v121, v121
  s_nop 0
  v_sub_f32 v124, 0, v120
  v_mov_b32 v125, v124
  v_mov_b32 v126, v121
  v_mov_b32 v127, v121
  v_pk_add_f32 v[160:161], v[160:161], v[124:125]
  v_cvt_pk_bf16_f32 v208, v160, v161
  v_lshlrev_b32 v160, 16, v208
  v_and_b32 v161, s26, v208
  v_pk_mul_f32 v[160:161], v[160:161], v[126:127]
  v_cvt_pk_bf16_f32 v32, v160, v161
  v_pk_add_f32 v[162:163], v[162:163], v[124:125]
  v_cvt_pk_bf16_f32 v208, v162, v163
  v_lshlrev_b32 v162, 16, v208
  v_and_b32 v163, s26, v208
  v_pk_mul_f32 v[162:163], v[162:163], v[126:127]
  v_cvt_pk_bf16_f32 v33, v162, v163
  v_pk_add_f32 v[164:165], v[164:165], v[124:125]
  v_cvt_pk_bf16_f32 v208, v164, v165
  v_lshlrev_b32 v164, 16, v208
  v_and_b32 v165, s26, v208
  v_pk_mul_f32 v[164:165], v[164:165], v[126:127]
  v_cvt_pk_bf16_f32 v34, v164, v165
  v_pk_add_f32 v[166:167], v[166:167], v[124:125]
  v_cvt_pk_bf16_f32 v208, v166, v167
  v_lshlrev_b32 v166, 16, v208
  v_and_b32 v167, s26, v208
  v_pk_mul_f32 v[166:167], v[166:167], v[126:127]
  v_cvt_pk_bf16_f32 v35, v166, v167
  v_pk_add_f32 v[168:169], v[168:169], v[124:125]
  v_cvt_pk_bf16_f32 v208, v168, v169
  v_lshlrev_b32 v168, 16, v208
  v_and_b32 v169, s26, v208
  v_pk_mul_f32 v[168:169], v[168:169], v[126:127]
  v_cvt_pk_bf16_f32 v36, v168, v169
  v_pk_add_f32 v[170:171], v[170:171], v[124:125]
  v_cvt_pk_bf16_f32 v208, v170, v171
  v_lshlrev_b32 v170, 16, v208
  v_and_b32 v171, s26, v208
  v_pk_mul_f32 v[170:171], v[170:171], v[126:127]
  v_cvt_pk_bf16_f32 v37, v170, v171
  v_pk_add_f32 v[172:173], v[172:173], v[124:125]
  v_cvt_pk_bf16_f32 v208, v172, v173
  v_lshlrev_b32 v172, 16, v208
  v_and_b32 v173, s26, v208
  v_pk_mul_f32 v[172:173], v[172:173], v[126:127]
  v_cvt_pk_bf16_f32 v38, v172, v173
  v_pk_add_f32 v[174:175], v[174:175], v[124:125]
  v_cvt_pk_bf16_f32 v208, v174, v175
  v_lshlrev_b32 v174, 16, v208
  v_and_b32 v175, s26, v208
  v_pk_mul_f32 v[174:175], v[174:175], v[126:127]
  v_cvt_pk_bf16_f32 v39, v174, v175
  ds_write_b64 v197, v[32:33]
  ds_write_b64 v198, v[34:35]
  ds_write_b64 v199, v[36:37]
  ds_write_b64 v200, v[38:39]
  ds_read_b128 v[12:15], v201 offset:0
  ds_read_b128 v[16:19], v201 offset:1024
  s_waitcnt lgkmcnt(1)
  buffer_store_dwordx4 v[12:15], v202, s[48:51], s25 offen offset:0 sc1
  s_waitcnt lgkmcnt(0)
  buffer_store_dwordx4 v[16:19], v202, s[48:51], s25 offen offset:1024 sc1
  ds_write_b64 v197, v[4:5]
  ds_write_b64 v198, v[6:7]
  ds_write_b64 v199, v[8:9]
  ds_write_b64 v200, v[10:11]
  ds_read_b128 v[120:123], v201 offset:0
  ds_read_b128 v[124:127], v201 offset:1024
  s_waitcnt lgkmcnt(1)
  buffer_store_dwordx4 v[120:123], v202, s[12:15], s18 offen offset:0 sc1
  s_waitcnt lgkmcnt(0)
  buffer_store_dwordx4 v[124:127], v202, s[12:15], s18 offen offset:1024 sc1
  s_waitcnt vmcnt(2) lgkmcnt(0)
  s_barrier
  s_cmp_lg_u32 s16, 0
  s_cbranch_scc1 arr_47
  s_add_u32 s64, s30, 71401472
  s_addc_u32 s65, s31, 0
  s_mov_b32 s66, 32768
  s_mov_b32 s67, 0x20000
  s_and_b32 s3, s2, 15
  s_lshl_b32 s3, s3, 8
  v_lshlrev_b32 v250, 12, v0
  v_add_u32 v250, s3, v250
  v_mov_b32 v251, 1
  s_mov_b64 exec, 0xff
  buffer_atomic_add v251, v250, s[64:67], 0 offen sc1
  s_mov_b64 exec, -1
arr_47:
  s_and_b32 s3, s2, 7
  s_lshr_b32 s29, s2, 3
  s_cmp_ge_u32 s29, 28
  s_cbranch_scc1 g1_skip_48
  s_and_b32 s18, s3, 3
  s_lshl_b32 s18, s18, 2
  s_and_b32 s23, s29, 3
  s_add_u32 s18, s18, s23
  s_mov_b32 s40, s18
  s_lshl_b32 s18, s18, 7
  s_lshr_b32 s17, s3, 2
  s_mul_i32 s17, s17, 7
  s_lshr_b32 s23, s29, 2
  s_add_u32 s17, s17, s23
  s_mov_b32 s41, s17
  s_lshl_b32 s17, s17, 7
  s_mov_b32 s4, s88
  s_mov_b32 s5, s89
  s_mov_b32 s6, 7340032
  s_mov_b32 s7, 0x20000
  s_add_u32 s8, s30, 33554432
  s_addc_u32 s9, s31, 0
  s_mov_b32 s10, 4194304
  s_mov_b32 s11, 0x20000
  s_cmp_lt_u32 s16, 4
  s_cbranch_scc1 g1_cons_49
  s_sub_u32 s25, s16, 4
  s_lshl_b32 s23, s25, 6
  s_add_u32 s23, s23, 0
  v_add_u32 v13, s23, v0
  v_lshrrev_b32 v14, 5, v13
  v_and_b32 v13, 31, v13
  v_and_b32 v15, 3, v14
  v_lshlrev_b32 v15, 1, v15
  v_xor_b32 v13, v13, v15
  v_and_b32 v15, 8, v14
  v_xor_b32 v13, v13, v15
  v_bfe_u32 v15, v13, 3, 1
  v_mul_u32_u24 v15, 3584, v15
  v_bfe_u32 v1, v13, 4, 1
  v_lshl_add_u32 v15, v1, 7, v15
  v_and_b32 v13, 7, v13
  v_lshl_add_u32 v13, v13, 4, v15
  s_mov_b32 s24, 7168
  v_mul_lo_u32 v14, v14, s24
  v_add_u32 v1, v13, v14
  s_lshl_b32 s23, s25, 6
  s_add_u32 s23, s23, 256
  v_add_u32 v13, s23, v0
  v_lshrrev_b32 v14, 5, v13
  v_and_b32 v13, 31, v13
  v_and_b32 v15, 3, v14
  v_lshlrev_b32 v15, 1, v15
  v_xor_b32 v13, v13, v15
  v_and_b32 v15, 8, v14
  v_xor_b32 v13, v13, v15
  v_bfe_u32 v15, v13, 3, 1
  v_mul_u32_u24 v15, 3584, v15
  v_bfe_u32 v2, v13, 4, 1
  v_lshl_add_u32 v15, v2, 7, v15
  v_and_b32 v13, 7, v13
  v_lshl_add_u32 v13, v13, 4, v15
  s_mov_b32 s24, 7168
  v_mul_lo_u32 v14, v14, s24
  v_add_u32 v2, v13, v14
  s_lshl_b32 s23, s25, 6
  s_add_u32 s23, s23, 512
  v_add_u32 v13, s23, v0
  v_lshrrev_b32 v14, 5, v13
  v_and_b32 v13, 31, v13
  v_and_b32 v15, 3, v14
  v_lshlrev_b32 v15, 1, v15
  v_xor_b32 v13, v13, v15
  v_and_b32 v15, 8, v14
  v_xor_b32 v13, v13, v15
  v_bfe_u32 v15, v13, 3, 1
  v_mul_u32_u24 v15, 3584, v15
  v_bfe_u32 v3, v13, 4, 1
  v_lshl_add_u32 v15, v3, 7, v15
  v_and_b32 v13, 7, v13
  v_lshl_add_u32 v13, v13, 4, v15
  s_mov_b32 s24, 7168
  v_mul_lo_u32 v14, v14, s24
  v_add_u32 v3, v13, v14
  s_lshl_b32 s23, s25, 6
  s_add_u32 s23, s23, 768
  v_add_u32 v13, s23, v0
  v_lshrrev_b32 v14, 5, v13
  v_and_b32 v13, 31, v13
  v_and_b32 v15, 3, v14
  v_lshlrev_b32 v15, 1, v15
  v_xor_b32 v13, v13, v15
  v_and_b32 v15, 8, v14
  v_xor_b32 v13, v13, v15
  v_bfe_u32 v15, v13, 3, 1
  v_mul_u32_u24 v15, 3584, v15
  v_bfe_u32 v4, v13, 4, 1
  v_lshl_add_u32 v15, v4, 7, v15
  v_and_b32 v13, 7, v13
  v_lshl_add_u32 v13, v13, 4, v15
  s_mov_b32 s24, 7168
  v_mul_lo_u32 v14, v14, s24
  v_add_u32 v4, v13, v14
  s_lshl_b32 s23, s25, 6
  s_add_u32 s23, s23, 1024
  v_add_u32 v13, s23, v0
  v_lshrrev_b32 v14, 5, v13
  v_and_b32 v13, 31, v13
  v_and_b32 v15, 3, v14
  v_lshlrev_b32 v15, 1, v15
  v_xor_b32 v13, v13, v15
  v_and_b32 v15, 8, v14
  v_xor_b32 v13, v13, v15
  v_bfe_u32 v15, v13, 3, 1
  v_mul_u32_u24 v15, 3584, v15
  v_bfe_u32 v5, v13, 4, 1
  v_lshl_add_u32 v15, v5, 7, v15
  v_and_b32 v13, 7, v13
  v_lshl_add_u32 v13, v13, 4, v15
  s_mov_b32 s24, 7168
  v_mul_lo_u32 v14, v14, s24
  v_add_u32 v5, v13, v14
  s_lshl_b32 s23, s25, 6
  s_add_u32 s23, s23, 1280
  v_add_u32 v13, s23, v0
  v_lshrrev_b32 v14, 5, v13
  v_and_b32 v13, 31, v13
  v_and_b32 v15, 3, v14
  v_lshlrev_b32 v15, 1, v15
  v_xor_b32 v13, v13, v15
  v_and_b32 v15, 8, v14
  v_xor_b32 v13, v13, v15
  v_bfe_u32 v15, v13, 3, 1
  v_mul_u32_u24 v15, 3584, v15
  v_bfe_u32 v6, v13, 4, 1
  v_lshl_add_u32 v15, v6, 7, v15
  v_and_b32 v13, 7, v13
  v_lshl_add_u32 v13, v13, 4, v15
  s_mov_b32 s24, 7168
  v_mul_lo_u32 v14, v14, s24
  v_add_u32 v6, v13, v14
  s_lshl_b32 s23, s25, 6
  s_add_u32 s23, s23, 1536
  v_add_u32 v13, s23, v0
  v_lshrrev_b32 v14, 5, v13
  v_and_b32 v13, 31, v13
  v_and_b32 v15, 3, v14
  v_lshlrev_b32 v15, 1, v15
  v_xor_b32 v13, v13, v15
  v_and_b32 v15, 8, v14
  v_xor_b32 v13, v13, v15
  v_bfe_u32 v15, v13, 3, 1
  v_mul_u32_u24 v15, 3584, v15
  v_bfe_u32 v7, v13, 4, 1
  v_lshl_add_u32 v15, v7, 7, v15
  v_and_b32 v13, 7, v13
  v_lshl_add_u32 v13, v13, 4, v15
  s_mov_b32 s24, 7168
  v_mul_lo_u32 v14, v14, s24
  v_add_u32 v7, v13, v14
  s_lshl_b32 s23, s25, 6
  s_add_u32 s23, s23, 1792
  v_add_u32 v13, s23, v0
  v_lshrrev_b32 v14, 5, v13
  v_and_b32 v13, 31, v13
  v_and_b32 v15, 3, v14
  v_lshlrev_b32 v15, 1, v15
  v_xor_b32 v13, v13, v15
  v_and_b32 v15, 8, v14
  v_xor_b32 v13, v13, v15
  v_bfe_u32 v15, v13, 3, 1
  v_mul_u32_u24 v15, 3584, v15
  v_bfe_u32 v8, v13, 4, 1
  v_lshl_add_u32 v15, v8, 7, v15
  v_and_b32 v13, 7, v13
  v_lshl_add_u32 v13, v13, 4, v15
  s_mov_b32 s24, 7168
  v_mul_lo_u32 v14, v14, s24
  v_add_u32 v8, v13, v14
  s_and_b32 s23, s25, 1
  s_lshl_b32 s23, s23, 2
  v_lshrrev_b32 v13, 4, v0
  v_xor_b32 v13, s23, v13
  v_and_b32 v14, 7, v0
  v_xor_b32 v13, v13, v14
  v_lshlrev_b32 v13, 4, v13
  s_lshl_b32 s23, s25, 3
  s_add_u32 s23, s23, 0
  v_lshrrev_b32 v14, 3, v0
  v_add_u32 v14, s23, v14
  s_mov_b32 s24, 2048
  v_mul_lo_u32 v14, v14, s24
  v_add_u32 v9, v13, v14
  s_and_b32 s23, s25, 1
  s_lshl_b32 s23, s23, 2
  v_lshrrev_b32 v13, 4, v0
  v_xor_b32 v13, s23, v13
  v_and_b32 v14, 7, v0
  v_xor_b32 v13, v13, v14
  v_lshlrev_b32 v13, 4, v13
  s_lshl_b32 s23, s25, 3
  s_add_u32 s23, s23, 32
  v_lshrrev_b32 v14, 3, v0
  v_add_u32 v14, s23, v14
  s_mov_b32 s24, 2048
  v_mul_lo_u32 v14, v14, s24
  v_add_u32 v10, v13, v14
  s_and_b32 s23, s25, 1
  s_lshl_b32 s23, s23, 2
  v_lshrrev_b32 v13, 4, v0
  v_xor_b32 v13, s23, v13
  v_and_b32 v14, 7, v0
  v_xor_b32 v13, v13, v14
  v_lshlrev_b32 v13, 4, v13
  s_lshl_b32 s23, s25, 3
  s_add_u32 s23, s23, 64
  v_lshrrev_b32 v14, 3, v0
  v_add_u32 v14, s23, v14
  s_mov_b32 s24, 2048
  v_mul_lo_u32 v14, v14, s24
  v_add_u32 v11, v13, v14
  s_and_b32 s23, s25, 1
  s_lshl_b32 s23, s23, 2
  v_lshrrev_b32 v13, 4, v0
  v_xor_b32 v13, s23, v13
  v_and_b32 v14, 7, v0
  v_xor_b32 v13, v13, v14
  v_lshlrev_b32 v13, 4, v13
  s_lshl_b32 s23, s25, 3
  s_add_u32 s23, s23, 96
  v_lshrrev_b32 v14, 3, v0
  v_add_u32 v14, s23, v14
  s_mov_b32 s24, 2048
  v_mul_lo_u32 v14, v14, s24
  v_add_u32 v12, v13, v14
  s_lshl_b32 s19, s17, 1
  s_mul_i32 s20, s18, 2048
  s_lshl_b32 s21, s25, 10
  s_add_u32 s26, s21, 147456
  s_add_u32 m0, s21, 0
  s_nop 0
  buffer_load_dwordx4 v1, s[4:7], s19 offen  lds
  s_add_u32 m0, s21, 4096
  s_nop 0
  buffer_load_dwordx4 v2, s[4:7], s19 offen  lds
  s_add_u32 m0, s21, 8192
  s_nop 0
  buffer_load_dwordx4 v3, s[4:7], s19 offen  lds
  s_add_u32 m0, s21, 12288
  s_nop 0
  buffer_load_dwordx4 v4, s[4:7], s19 offen  lds
  s_add_u32 m0, s21, 16384
  s_nop 0
  buffer_load_dwordx4 v5, s[4:7], s19 offen  lds
  s_add_u32 m0, s21, 20480
  s_nop 0
  buffer_load_dwordx4 v6, s[4:7], s19 offen  lds
  s_add_u32 m0, s21, 24576
  s_nop 0
  buffer_load_dwordx4 v7, s[4:7], s19 offen  lds
  s_add_u32 m0, s21, 28672
  s_nop 0
  buffer_load_dwordx4 v8, s[4:7], s19 offen  lds
  s_add_u32 s19, s19, 458752
  s_add_u32 s21, s21, 49152
  s_cmp_ge_u32 s21, s26
  s_cselect_b32 s23, 147456, 0
  s_sub_u32 s21, s21, s23
  s_add_u32 m0, s21, 0
  s_nop 0
  buffer_load_dwordx4 v1, s[4:7], s19 offen  lds
  s_add_u32 m0, s21, 4096
  s_nop 0
  buffer_load_dwordx4 v2, s[4:7], s19 offen  lds
  s_add_u32 m0, s21, 8192
  s_nop 0
  buffer_load_dwordx4 v3, s[4:7], s19 offen  lds
  s_add_u32 m0, s21, 12288
  s_nop 0
  buffer_load_dwordx4 v4, s[4:7], s19 offen  lds
  s_add_u32 m0, s21, 16384
  s_nop 0
  buffer_load_dwordx4 v5, s[4:7], s19 offen  lds
  s_add_u32 m0, s21, 20480
  s_nop 0
  buffer_load_dwordx4 v6, s[4:7], s19 offen  lds
  s_add_u32 m0, s21, 24576
  s_nop 0
  buffer_load_dwordx4 v7, s[4:7], s19 offen  lds
  s_add_u32 m0, s21, 28672
  s_nop 0
  buffer_load_dwordx4 v8, s[4:7], s19 offen  lds
  s_add_u32 s19, s19, 458752
  s_add_u32 s21, s21, 49152
  s_cmp_ge_u32 s21, s26
  s_cselect_b32 s23, 147456, 0
  s_sub_u32 s21, s21, s23
  s_add_u32 m0, s21, 0
  s_nop 0
  buffer_load_dwordx4 v1, s[4:7], s19 offen  lds
  s_add_u32 m0, s21, 4096
  s_nop 0
  buffer_load_dwordx4 v2, s[4:7], s19 offen  lds
  s_add_u32 m0, s21, 8192
  s_nop 0
  buffer_load_dwordx4 v3, s[4:7], s19 offen  lds
  s_add_u32 m0, s21, 12288
  s_nop 0
  buffer_load_dwordx4 v4, s[4:7], s19 offen  lds
  s_add_u32 m0, s21, 16384
  s_nop 0
  buffer_load_dwordx4 v5, s[4:7], s19 offen  lds
  s_add_u32 m0, s21, 20480
  s_nop 0
  buffer_load_dwordx4 v6, s[4:7], s19 offen  lds
  s_add_u32 m0, s21, 24576
  s_nop 0
  buffer_load_dwordx4 v7, s[4:7], s19 offen  lds
  s_add_u32 m0, s21, 28672
  s_nop 0
  buffer_load_dwordx4 v8, s[4:7], s19 offen  lds
  s_add_u32 s19, s19, 458752
  s_add_u32 s21, s21, 49152
  s_cmp_ge_u32 s21, s26
  s_cselect_b32 s23, 147456, 0
  s_sub_u32 s21, s21, s23
  s_barrier
  s_add_u32 m0, s21, 32768
  s_nop 0
  buffer_load_dwordx4 v9, s[8:11], s20 offen sc1 lds
  s_add_u32 m0, s21, 36864
  s_nop 0
  buffer_load_dwordx4 v10, s[8:11], s20 offen sc1 lds
  s_add_u32 m0, s21, 40960
  s_nop 0
  buffer_load_dwordx4 v11, s[8:11], s20 offen sc1 lds
  s_add_u32 m0, s21, 45056
  s_nop 0
  buffer_load_dwordx4 v12, s[8:11], s20 offen sc1 lds
  s_add_u32 s20, s20, 128
  s_add_u32 s21, s21, 49152
  s_cmp_ge_u32 s21, s26
  s_cselect_b32 s23, 147456, 0
  s_sub_u32 s21, s21, s23
  s_add_u32 m0, s21, 32768
  s_nop 0
  buffer_load_dwordx4 v9, s[8:11], s20 offen sc1 lds
  s_add_u32 m0, s21, 36864
  s_nop 0
  buffer_load_dwordx4 v10, s[8:11], s20 offen sc1 lds
  s_add_u32 m0, s21, 40960
  s_nop 0
  buffer_load_dwordx4 v11, s[8:11], s20 offen sc1 lds
  s_add_u32 m0, s21, 45056
  s_nop 0
  buffer_load_dwordx4 v12, s[8:11], s20 offen sc1 lds
  s_add_u32 s20, s20, 128
  s_add_u32 s21, s21, 49152
  s_cmp_ge_u32 s21, s26
  s_cselect_b32 s23, 147456, 0
  s_sub_u32 s21, s21, s23
  s_add_u32 m0, s21, 32768
  s_nop 0
  buffer_load_dwordx4 v9, s[8:11], s20 offen sc1 lds
  s_add_u32 m0, s21, 36864
  s_nop 0
  buffer_load_dwordx4 v10, s[8:11], s20 offen sc1 lds
  s_add_u32 m0, s21, 40960
  s_nop 0
  buffer_load_dwordx4 v11, s[8:11], s20 offen sc1 lds
  s_add_u32 m0, s21, 45056
  s_nop 0
  buffer_load_dwordx4 v12, s[8:11], s20 offen sc1 lds
  s_add_u32 s20, s20, 128
  s_add_u32 s21, s21, 49152
  s_cmp_ge_u32 s21, s26
  s_cselect_b32 s23, 147456, 0
  s_sub_u32 s21, s21, s23
  s_waitcnt vmcnt(8)
  s_barrier
  s_waitcnt vmcnt(4)
  s_barrier
  s_add_u32 m0, s21, 0
  s_nop 0
  buffer_load_dwordx4 v1, s[4:7], s19 offen  lds
  s_add_u32 m0, s21, 4096
  s_nop 0
  buffer_load_dwordx4 v2, s[4:7], s19 offen  lds
  s_add_u32 m0, s21, 8192
  s_nop 0
  buffer_load_dwordx4 v3, s[4:7], s19 offen  lds
  s_add_u32 m0, s21, 12288
  s_nop 0
  buffer_load_dwordx4 v4, s[4:7], s19 offen  lds
  s_add_u32 m0, s21, 16384
  s_nop 0
  buffer_load_dwordx4 v5, s[4:7], s19 offen  lds
  s_add_u32 m0, s21, 20480
  s_nop 0
  buffer_load_dwordx4 v6, s[4:7], s19 offen  lds
  s_add_u32 m0, s21, 24576
  s_nop 0
  buffer_load_dwordx4 v7, s[4:7], s19 offen  lds
  s_add_u32 m0, s21, 28672
  s_nop 0
  buffer_load_dwordx4 v8, s[4:7], s19 offen  lds
  s_add_u32 m0, s21, 32768
  s_nop 0
  buffer_load_dwordx4 v9, s[8:11], s20 offen sc1 lds
  s_add_u32 m0, s21, 36864
  s_nop 0
  buffer_load_dwordx4 v10, s[8:11], s20 offen sc1 lds
  s_add_u32 m0, s21, 40960
  s_nop 0
  buffer_load_dwordx4 v11, s[8:11], s20 offen sc1 lds
  s_add_u32 m0, s21, 45056
  s_nop 0
  buffer_load_dwordx4 v12, s[8:11], s20 offen sc1 lds
  s_add_u32 s19, s19, 458752
  s_add_u32 s20, s20, 128
  s_add_u32 s21, s21, 49152
  s_cmp_ge_u32 s21, s26
  s_cselect_b32 s23, 147456, 0
  s_sub_u32 s21, s21, s23
  s_waitcnt vmcnt(12)
  s_barrier
  s_add_u32 m0, s21, 0
  s_nop 0
  buffer_load_dwordx4 v1, s[4:7], s19 offen  lds
  s_add_u32 m0, s21, 4096
  s_nop 0
  buffer_load_dwordx4 v2, s[4:7], s19 offen  lds
  s_add_u32 m0, s21, 8192
  s_nop 0
  buffer_load_dwordx4 v3, s[4:7], s19 offen  lds
  s_add_u32 m0, s21, 12288
  s_nop 0
  buffer_load_dwordx4 v4, s[4:7], s19 offen  lds
  s_add_u32 m0, s21, 16384
  s_nop 0
  buffer_load_dwordx4 v5, s[4:7], s19 offen  lds
  s_add_u32 m0, s21, 20480
  s_nop 0
  buffer_load_dwordx4 v6, s[4:7], s19 offen  lds
  s_add_u32 m0, s21, 24576
  s_nop 0
  buffer_load_dwordx4 v7, s[4:7], s19 offen  lds
  s_add_u32 m0, s21, 28672
  s_nop 0
  buffer_load_dwordx4 v8, s[4:7], s19 offen  lds
  s_add_u32 m0, s21, 32768
  s_nop 0
  buffer_load_dwordx4 v9, s[8:11], s20 offen sc1 lds
  s_add_u32 m0, s21, 36864
  s_nop 0
  buffer_load_dwordx4 v10, s[8:11], s20 offen sc1 lds
  s_add_u32 m0, s21, 40960
  s_nop 0
  buffer_load_dwordx4 v11, s[8:11], s20 offen sc1 lds
  s_add_u32 m0, s21, 45056
  s_nop 0
  buffer_load_dwordx4 v12, s[8:11], s20 offen sc1 lds
  s_add_u32 s19, s19, 458752
  s_add_u32 s20, s20, 128
  s_add_u32 s21, s21, 49152
  s_cmp_ge_u32 s21, s26
  s_cselect_b32 s23, 147456, 0
  s_sub_u32 s21, s21, s23
  s_mov_b32 s22, 11
g1_pl_51:
  s_waitcnt vmcnt(12)
  s_barrier
  s_add_u32 m0, s21, 0
  s_nop 0
  buffer_load_dwordx4 v1, s[4:7], s19 offen  lds
  s_add_u32 m0, s21, 4096
  s_nop 0
  buffer_load_dwordx4 v2, s[4:7], s19 offen  lds
  s_add_u32 m0, s21, 8192
  s_nop 0
  buffer_load_dwordx4 v3, s[4:7], s19 offen  lds
  s_add_u32 m0, s21, 12288
  s_nop 0
  buffer_load_dwordx4 v4, s[4:7], s19 offen  lds
  s_add_u32 m0, s21, 16384
  s_nop 0
  buffer_load_dwordx4 v5, s[4:7], s19 offen  lds
  s_add_u32 m0, s21, 20480
  s_nop 0
  buffer_load_dwordx4 v6, s[4:7], s19 offen  lds
  s_add_u32 m0, s21, 24576
  s_nop 0
  buffer_load_dwordx4 v7, s[4:7], s19 offen  lds
  s_add_u32 m0, s21, 28672
  s_nop 0
  buffer_load_dwordx4 v8, s[4:7], s19 offen  lds
  s_add_u32 m0, s21, 32768
  s_nop 0
  buffer_load_dwordx4 v9, s[8:11], s20 offen sc1 lds
  s_add_u32 m0, s21, 36864
  s_nop 0
  buffer_load_dwordx4 v10, s[8:11], s20 offen sc1 lds
  s_add_u32 m0, s21, 40960
  s_nop 0
  buffer_load_dwordx4 v11, s[8:11], s20 offen sc1 lds
  s_add_u32 m0, s21, 45056
  s_nop 0
  buffer_load_dwordx4 v12, s[8:11], s20 offen sc1 lds
  s_add_u32 s19, s19, 458752
  s_add_u32 s20, s20, 128
  s_add_u32 s21, s21, 49152
  s_cmp_ge_u32 s21, s26
  s_cselect_b32 s23, 147456, 0
  s_sub_u32 s21, s21, s23
  s_sub_u32 s22, s22, 1
  s_cmp_lg_u32 s22, 0
  s_cbranch_scc1 g1_pl_51
  s_waitcnt vmcnt(12)
  s_barrier
  s_waitcnt vmcnt(0)
  s_barrier
  s_branch g1_end_50
g1_cons_49:
  s_and_b32 s27, s16, 1
  s_lshr_b32 s28, s16, 1
  v_lshrrev_b32 v16, 4, v0
  v_bfe_u32 v17, v0, 2, 2
  v_and_b32 v18, 1, v16
  v_lshlrev_b32 v18, 2, v18
  v_or_b32 v18, v18, v17
  v_lshl_add_u32 v16, v16, 3, v17
  s_mov_b32 s24, 512
  v_mul_lo_u32 v16, v16, s24
  s_mul_i32 s23, s27, 8
  s_add_u32 s23, s23, 0
  v_xor_b32 v18, s23, v18
  v_lshlrev_b32 v18, 5, v18
  v_add_u32 v16, v16, v18
  v_and_b32 v17, 3, v0
  v_lshlrev_b32 v17, 3, v17
  v_add_u32 v16, v16, v17
  v_add_u32 v3, 0, v16
  v_and_b32 v16, 15, v0
  v_lshrrev_b32 v17, 1, v16
  v_lshrrev_b32 v18, 4, v0
  v_xor_b32 v17, v17, v18
  v_lshlrev_b32 v17, 4, v17
  v_lshlrev_b32 v16, 7, v16
  v_add_u32 v16, v16, v17
  s_mul_i32 s23, s28, 8192
  s_add_u32 s23, s23, 32768
  v_add_u32 v4, s23, v16
  v_and_b32 v16, 15, v0
  v_lshrrev_b32 v17, 1, v16
  v_lshrrev_b32 v18, 4, v0
  v_xor_b32 v17, v17, v18
  v_xor_b32 v17, 4, v17
  v_lshlrev_b32 v17, 4, v17
  v_lshlrev_b32 v16, 7, v16
  v_add_u32 v16, v16, v17
  s_mul_i32 s23, s28, 8192
  s_add_u32 s23, s23, 32768
  v_add_u32 v5, s23, v16
  s_mov_b32 s21, 0
  v_add_u32 v6, s21, v3
  v_add_u32 v7, s21, v4
  v_add_u32 v8, s21, v5
  v_xor_b32 v9, 32, v6
  v_xor_b32 v10, 64, v6
  v_xor_b32 v11, 96, v6
  v_xor_b32 v12, 128, v6
  v_xor_b32 v13, 160, v6
  v_xor_b32 v14, 192, v6
  v_xor_b32 v15, 224, v6
  v_mov_b32 v112, 0
  v_mov_b32 v113, 0
  v_mov_b32 v114, 0
  v_mov_b32 v115, 0
  v_mov_b32 v116, 0
  v_mov_b32 v117, 0
  v_mov_b32 v118, 0
  v_mov_b32 v119, 0
  v_mov_b32 v120, 0
  v_mov_b32 v121, 0
  v_mov_b32 v122, 0
  v_mov_b32 v123, 0
  v_mov_b32 v124, 0
  v_mov_b32 v125, 0
  v_mov_b32 v126, 0
  v_mov_b32 v127, 0
  v_mov_b32 v128, 0
  v_mov_b32 v129, 0
  v_mov_b32 v130, 0
  v_mov_b32 v131, 0
  v_mov_b32 v132, 0
  v_mov_b32 v133, 0
  v_mov_b32 v134, 0
  v_mov_b32 v135, 0
  v_mov_b32 v136, 0
  v_mov_b32 v137, 0
  v_mov_b32 v138, 0
  v_mov_b32 v139, 0
  v_mov_b32 v140, 0
  v_mov_b32 v141, 0
  v_mov_b32 v142, 0
  v_mov_b32 v143, 0
  v_mov_b32 v144, 0
  v_mov_b32 v145, 0
  v_mov_b32 v146, 0
  v_mov_b32 v147, 0
  v_mov_b32 v148, 0
  v_mov_b32 v149, 0
  v_mov_b32 v150, 0
  v_mov_b32 v151, 0
  v_mov_b32 v152, 0
  v_mov_b32 v153, 0
  v_mov_b32 v154, 0
  v_mov_b32 v155, 0
  v_mov_b32 v156, 0
  v_mov_b32 v157, 0
  v_mov_b32 v158, 0
  v_mov_b32 v159, 0
  v_mov_b32 v160, 0
  v_mov_b32 v161, 0
  v_mov_b32 v162, 0
  v_mov_b32 v163, 0
  v_mov_b32 v164, 0
  v_mov_b32 v165, 0
  v_mov_b32 v166, 0
  v_mov_b32 v167, 0
  v_mov_b32 v168, 0
  v_mov_b32 v169, 0
  v_mov_b32 v170, 0
  v_mov_b32 v171, 0
  v_mov_b32 v172, 0
  v_mov_b32 v173, 0
  v_mov_b32 v174, 0
  v_mov_b32 v175, 0
  v_mov_b32 v176, 0
  v_mov_b32 v177, 0
  v_mov_b32 v178, 0
  v_mov_b32 v179, 0
  v_mov_b32 v180, 0
  v_mov_b32 v181, 0
  v_mov_b32 v182, 0
  v_mov_b32 v183, 0
  v_mov_b32 v184, 0
  v_mov_b32 v185, 0
  v_mov_b32 v186, 0
  v_mov_b32 v187, 0
  v_mov_b32 v188, 0
  v_mov_b32 v189, 0
  v_mov_b32 v190, 0
  v_mov_b32 v191, 0
  v_mov_b32 v192, 0
  v_mov_b32 v193, 0
  v_mov_b32 v194, 0
  v_mov_b32 v195, 0
  v_mov_b32 v196, 0
  v_mov_b32 v197, 0
  v_mov_b32 v198, 0
  v_mov_b32 v199, 0
  v_mov_b32 v200, 0
  v_mov_b32 v201, 0
  v_mov_b32 v202, 0
  v_mov_b32 v203, 0
  v_mov_b32 v204, 0
  v_mov_b32 v205, 0
  v_mov_b32 v206, 0
  v_mov_b32 v207, 0
  v_mov_b32 v208, 0
  v_mov_b32 v209, 0
  v_mov_b32 v210, 0
  v_mov_b32 v211, 0
  v_mov_b32 v212, 0
  v_mov_b32 v213, 0
  v_mov_b32 v214, 0
  v_mov_b32 v215, 0
  v_mov_b32 v216, 0
  v_mov_b32 v217, 0
  v_mov_b32 v218, 0
  v_mov_b32 v219, 0
  v_mov_b32 v220, 0
  v_mov_b32 v221, 0
  v_mov_b32 v222, 0
  v_mov_b32 v223, 0
  v_mov_b32 v224, 0
  v_mov_b32 v225, 0
  v_mov_b32 v226, 0
  v_mov_b32 v227, 0
  v_mov_b32 v228, 0
  v_mov_b32 v229, 0
  v_mov_b32 v230, 0
  v_mov_b32 v231, 0
  v_mov_b32 v232, 0
  v_mov_b32 v233, 0
  v_mov_b32 v234, 0
  v_mov_b32 v235, 0
  v_mov_b32 v236, 0
  v_mov_b32 v237, 0
  v_mov_b32 v238, 0
  v_mov_b32 v239, 0
  s_cmp_lg_u32 s16, 0
  s_cbranch_scc1 pw_52
  s_add_u32 s64, s30, 71401472
  s_addc_u32 s65, s31, 0
  s_mov_b32 s66, 32768
  s_mov_b32 s67, 0x20000
  s_bfe_u32 s3, s2, 0x30004
  s_lshl_b32 s3, s3, 12
  v_and_b32 v250, 15, v0
  v_lshlrev_b32 v250, 8, v250
  v_add_u32 v250, s3, v250
  s_mov_b32 s3, 0x20000
  buffer_load_dword v251, v250, s[64:67], 0 offen sc1
pl_53:
  s_waitcnt vmcnt(0)
  v_cmp_gt_u32 vcc, 16, v251
  s_sub_u32 s3, s3, 1
  s_cbranch_scc1 pd_54
  s_cmp_eq_u64 vcc, 0
  s_cbranch_scc1 pd_54
  s_sleep 1
  buffer_load_dword v251, v250, s[64:67], 0 offen sc1
  s_branch pl_53
pd_54:
pw_52:
  s_barrier
  s_barrier
  ds_read_b128 v[48:51], v7 offset:0
  ds_read_b64_tr_b16 v[16:17], v6 offset:0
  ds_read_b64_tr_b16 v[18:19], v6 offset:2048
  ds_read_b128 v[52:55], v7 offset:2048
  ds_read_b128 v[56:59], v7 offset:4096
  ds_read_b128 v[60:63], v7 offset:6144
  ds_read_b64_tr_b16 v[20:21], v9 offset:0
  ds_read_b64_tr_b16 v[22:23], v9 offset:2048
  ds_read_b64_tr_b16 v[24:25], v10 offset:0
  ds_read_b64_tr_b16 v[26:27], v10 offset:2048
  ds_read_b64_tr_b16 v[28:29], v11 offset:0
  ds_read_b64_tr_b16 v[30:31], v11 offset:2048
  ds_read_b64_tr_b16 v[32:33], v12 offset:0
  ds_read_b64_tr_b16 v[34:35], v12 offset:2048
  ds_read_b64_tr_b16 v[36:37], v13 offset:0
  ds_read_b64_tr_b16 v[38:39], v13 offset:2048
  ds_read_b64_tr_b16 v[40:41], v14 offset:0
  ds_read_b64_tr_b16 v[42:43], v14 offset:2048
  ds_read_b64_tr_b16 v[44:45], v15 offset:0
  ds_read_b64_tr_b16 v[46:47], v15 offset:2048
  s_waitcnt lgkmcnt(0)
  s_mov_b32 s22, 15
g1_cl_55:
  v_mfma_f32_16x16x32_bf16 v[112:115], v[16:19], v[48:51], v[112:115]
  ds_read_b128 v[96:99], v8 offset:0
  ds_read_b64_tr_b16 v[64:65], v6 offset:16384
  v_mfma_f32_16x16x32_bf16 v[116:119], v[16:19], v[52:55], v[116:119]
  ds_read_b64_tr_b16 v[66:67], v6 offset:18432
  ds_read_b128 v[100:103], v8 offset:2048
  v_mfma_f32_16x16x32_bf16 v[120:123], v[16:19], v[56:59], v[120:123]
  ds_read_b128 v[104:107], v8 offset:4096
  ds_read_b128 v[108:111], v8 offset:6144
  v_mfma_f32_16x16x32_bf16 v[124:127], v[16:19], v[60:63], v[124:127]
  ds_read_b64_tr_b16 v[68:69], v9 offset:16384
  ds_read_b64_tr_b16 v[70:71], v9 offset:18432
  v_mfma_f32_16x16x32_bf16 v[128:131], v[20:23], v[48:51], v[128:131]
  ds_read_b64_tr_b16 v[72:73], v10 offset:16384
  ds_read_b64_tr_b16 v[74:75], v10 offset:18432
  v_mfma_f32_16x16x32_bf16 v[132:135], v[20:23], v[52:55], v[132:135]
  ds_read_b64_tr_b16 v[76:77], v11 offset:16384
  ds_read_b64_tr_b16 v[78:79], v11 offset:18432
  v_mfma_f32_16x16x32_bf16 v[136:139], v[20:23], v[56:59], v[136:139]
  ds_read_b64_tr_b16 v[80:81], v12 offset:16384
  ds_read_b64_tr_b16 v[82:83], v12 offset:18432
  v_mfma_f32_16x16x32_bf16 v[140:143], v[20:23], v[60:63], v[140:143]
  ds_read_b64_tr_b16 v[84:85], v13 offset:16384
  ds_read_b64_tr_b16 v[86:87], v13 offset:18432
  v_mfma_f32_16x16x32_bf16 v[144:147], v[24:27], v[48:51], v[144:147]
  ds_read_b64_tr_b16 v[88:89], v14 offset:16384
  ds_read_b64_tr_b16 v[90:91], v14 offset:18432
  v_mfma_f32_16x16x32_bf16 v[148:151], v[24:27], v[52:55], v[148:151]
  ds_read_b64_tr_b16 v[92:93], v15 offset:16384
  ds_read_b64_tr_b16 v[94:95], v15 offset:18432
  v_mfma_f32_16x16x32_bf16 v[152:155], v[24:27], v[56:59], v[152:155]
  s_add_u32 s21, s21, 49152
  s_cmp_ge_u32 s21, 147456
  v_mfma_f32_16x16x32_bf16 v[156:159], v[24:27], v[60:63], v[156:159]
  s_cselect_b32 s23, 147456, 0
  s_sub_u32 s21, s21, s23
  v_mfma_f32_16x16x32_bf16 v[160:163], v[28:31], v[48:51], v[160:163]
  v_add_u32 v6, s21, v3
  v_add_u32 v7, s21, v4
  v_mfma_f32_16x16x32_bf16 v[164:167], v[28:31], v[52:55], v[164:167]
  v_add_u32 v8, s21, v5
  v_xor_b32 v9, 32, v6
  v_mfma_f32_16x16x32_bf16 v[168:171], v[28:31], v[56:59], v[168:171]
  v_xor_b32 v10, 64, v6
  v_xor_b32 v11, 96, v6
  v_mfma_f32_16x16x32_bf16 v[172:175], v[28:31], v[60:63], v[172:175]
  v_xor_b32 v12, 128, v6
  v_xor_b32 v13, 160, v6
  v_mfma_f32_16x16x32_bf16 v[176:179], v[32:35], v[48:51], v[176:179]
  v_xor_b32 v14, 192, v6
  v_xor_b32 v15, 224, v6
  v_mfma_f32_16x16x32_bf16 v[180:183], v[32:35], v[52:55], v[180:183]
  v_mfma_f32_16x16x32_bf16 v[184:187], v[32:35], v[56:59], v[184:187]
  v_mfma_f32_16x16x32_bf16 v[188:191], v[32:35], v[60:63], v[188:191]
  v_mfma_f32_16x16x32_bf16 v[192:195], v[36:39], v[48:51], v[192:195]
  v_mfma_f32_16x16x32_bf16 v[196:199], v[36:39], v[52:55], v[196:199]
  v_mfma_f32_16x16x32_bf16 v[200:203], v[36:39], v[56:59], v[200:203]
  v_mfma_f32_16x16x32_bf16 v[204:207], v[36:39], v[60:63], v[204:207]
  v_mfma_f32_16x16x32_bf16 v[208:211], v[40:43], v[48:51], v[208:211]
  v_mfma_f32_16x16x32_bf16 v[212:215], v[40:43], v[52:55], v[212:215]
  v_mfma_f32_16x16x32_bf16 v[216:219], v[40:43], v[56:59], v[216:219]
  v_mfma_f32_16x16x32_bf16 v[220:223], v[40:43], v[60:63], v[220:223]
  v_mfma_f32_16x16x32_bf16 v[224:227], v[44:47], v[48:51], v[224:227]
  v_mfma_f32_16x16x32_bf16 v[228:231], v[44:47], v[52:55], v[228:231]
  v_mfma_f32_16x16x32_bf16 v[232:235], v[44:47], v[56:59], v[232:235]
  v_mfma_f32_16x16x32_bf16 v[236:239], v[44:47], v[60:63], v[236:239]
  s_waitcnt lgkmcnt(0)
  s_barrier
  v_mfma_f32_16x16x32_bf16 v[112:115], v[64:67], v[96:99], v[112:115]
  ds_read_b128 v[48:51], v7 offset:0
  ds_read_b64_tr_b16 v[16:17], v6 offset:0
  v_mfma_f32_16x16x32_bf16 v[116:119], v[64:67], v[100:103], v[116:119]
  ds_read_b64_tr_b16 v[18:19], v6 offset:2048
  ds_read_b128 v[52:55], v7 offset:2048
  v_mfma_f32_16x16x32_bf16 v[120:123], v[64:67], v[104:107], v[120:123]
  ds_read_b128 v[56:59], v7 offset:4096
  ds_read_b128 v[60:63], v7 offset:6144
  v_mfma_f32_16x16x32_bf16 v[124:127], v[64:67], v[108:111], v[124:127]
  ds_read_b64_tr_b16 v[20:21], v9 offset:0
  ds_read_b64_tr_b16 v[22:23], v9 offset:2048
  v_mfma_f32_16x16x32_bf16 v[128:131], v[68:71], v[96:99], v[128:131]
  ds_read_b64_tr_b16 v[24:25], v10 offset:0
  ds_read_b64_tr_b16 v[26:27], v10 offset:2048
  v_mfma_f32_16x16x32_bf16 v[132:135], v[68:71], v[100:103], v[132:135]
  ds_read_b64_tr_b16 v[28:29], v11 offset:0
  ds_read_b64_tr_b16 v[30:31], v11 offset:2048
  v_mfma_f32_16x16x32_bf16 v[136:139], v[68:71], v[104:107], v[136:139]
  ds_read_b64_tr_b16 v[32:33], v12 offset:0
  ds_read_b64_tr_b16 v[34:35], v12 offset:2048
  v_mfma_f32_16x16x32_bf16 v[140:143], v[68:71], v[108:111], v[140:143]
  ds_read_b64_tr_b16 v[36:37], v13 offset:0
  ds_read_b64_tr_b16 v[38:39], v13 offset:2048
  v_mfma_f32_16x16x32_bf16 v[144:147], v[72:75], v[96:99], v[144:147]
  ds_read_b64_tr_b16 v[40:41], v14 offset:0
  ds_read_b64_tr_b16 v[42:43], v14 offset:2048
  v_mfma_f32_16x16x32_bf16 v[148:151], v[72:75], v[100:103], v[148:151]
  ds_read_b64_tr_b16 v[44:45], v15 offset:0
  ds_read_b64_tr_b16 v[46:47], v15 offset:2048
  v_mfma_f32_16x16x32_bf16 v[152:155], v[72:75], v[104:107], v[152:155]
  s_sub_u32 s22, s22, 1
  v_mfma_f32_16x16x32_bf16 v[156:159], v[72:75], v[108:111], v[156:159]
  v_mfma_f32_16x16x32_bf16 v[160:163], v[76:79], v[96:99], v[160:163]
  v_mfma_f32_16x16x32_bf16 v[164:167], v[76:79], v[100:103], v[164:167]
  v_mfma_f32_16x16x32_bf16 v[168:171], v[76:79], v[104:107], v[168:171]
  v_mfma_f32_16x16x32_bf16 v[172:175], v[76:79], v[108:111], v[172:175]
  v_mfma_f32_16x16x32_bf16 v[176:179], v[80:83], v[96:99], v[176:179]
  v_mfma_f32_16x16x32_bf16 v[180:183], v[80:83], v[100:103], v[180:183]
  v_mfma_f32_16x16x32_bf16 v[184:187], v[80:83], v[104:107], v[184:187]
  v_mfma_f32_16x16x32_bf16 v[188:191], v[80:83], v[108:111], v[188:191]
  v_mfma_f32_16x16x32_bf16 v[192:195], v[84:87], v[96:99], v[192:195]
  v_mfma_f32_16x16x32_bf16 v[196:199], v[84:87], v[100:103], v[196:199]
  v_mfma_f32_16x16x32_bf16 v[200:203], v[84:87], v[104:107], v[200:203]
  v_mfma_f32_16x16x32_bf16 v[204:207], v[84:87], v[108:111], v[204:207]
  v_mfma_f32_16x16x32_bf16 v[208:211], v[88:91], v[96:99], v[208:211]
  v_mfma_f32_16x16x32_bf16 v[212:215], v[88:91], v[100:103], v[212:215]
  v_mfma_f32_16x16x32_bf16 v[216:219], v[88:91], v[104:107], v[216:219]
  v_mfma_f32_16x16x32_bf16 v[220:223], v[88:91], v[108:111], v[220:223]
  v_mfma_f32_16x16x32_bf16 v[224:227], v[92:95], v[96:99], v[224:227]
  v_mfma_f32_16x16x32_bf16 v[228:231], v[92:95], v[100:103], v[228:231]
  v_mfma_f32_16x16x32_bf16 v[232:235], v[92:95], v[104:107], v[232:235]
  v_mfma_f32_16x16x32_bf16 v[236:239], v[92:95], v[108:111], v[236:239]
  s_waitcnt lgkmcnt(0)
  s_cmp_lg_u32 s22, 0
  s_cbranch_scc1 g1_cl_55
  v_mfma_f32_16x16x32_bf16 v[112:115], v[16:19], v[48:51], v[112:115]
  ds_read_b128 v[96:99], v8 offset:0
  ds_read_b64_tr_b16 v[64:65], v6 offset:16384
  v_mfma_f32_16x16x32_bf16 v[116:119], v[16:19], v[52:55], v[116:119]
  ds_read_b64_tr_b16 v[66:67], v6 offset:18432
  ds_read_b128 v[100:103], v8 offset:2048
  v_mfma_f32_16x16x32_bf16 v[120:123], v[16:19], v[56:59], v[120:123]
  ds_read_b128 v[104:107], v8 offset:4096
  ds_read_b128 v[108:111], v8 offset:6144
  v_mfma_f32_16x16x32_bf16 v[124:127], v[16:19], v[60:63], v[124:127]
  ds_read_b64_tr_b16 v[68:69], v9 offset:16384
  ds_read_b64_tr_b16 v[70:71], v9 offset:18432
  v_mfma_f32_16x16x32_bf16 v[128:131], v[20:23], v[48:51], v[128:131]
  ds_read_b64_tr_b16 v[72:73], v10 offset:16384
  ds_read_b64_tr_b16 v[74:75], v10 offset:18432
  v_mfma_f32_16x16x32_bf16 v[132:135], v[20:23], v[52:55], v[132:135]
  ds_read_b64_tr_b16 v[76:77], v11 offset:16384
  ds_read_b64_tr_b16 v[78:79], v11 offset:18432
  v_mfma_f32_16x16x32_bf16 v[136:139], v[20:23], v[56:59], v[136:139]
  ds_read_b64_tr_b16 v[80:81], v12 offset:16384
  ds_read_b64_tr_b16 v[82:83], v12 offset:18432
  v_mfma_f32_16x16x32_bf16 v[140:143], v[20:23], v[60:63], v[140:143]
  ds_read_b64_tr_b16 v[84:85], v13 offset:16384
  ds_read_b64_tr_b16 v[86:87], v13 offset:18432
  v_mfma_f32_16x16x32_bf16 v[144:147], v[24:27], v[48:51], v[144:147]
  ds_read_b64_tr_b16 v[88:89], v14 offset:16384
  ds_read_b64_tr_b16 v[90:91], v14 offset:18432
  v_mfma_f32_16x16x32_bf16 v[148:151], v[24:27], v[52:55], v[148:151]
  ds_read_b64_tr_b16 v[92:93], v15 offset:16384
  ds_read_b64_tr_b16 v[94:95], v15 offset:18432
  v_mfma_f32_16x16x32_bf16 v[152:155], v[24:27], v[56:59], v[152:155]
  v_mfma_f32_16x16x32_bf16 v[156:159], v[24:27], v[60:63], v[156:159]
  v_mfma_f32_16x16x32_bf16 v[160:163], v[28:31], v[48:51], v[160:163]
  v_mfma_f32_16x16x32_bf16 v[164:167], v[28:31], v[52:55], v[164:167]
  v_mfma_f32_16x16x32_bf16 v[168:171], v[28:31], v[56:59], v[168:171]
  v_mfma_f32_16x16x32_bf16 v[172:175], v[28:31], v[60:63], v[172:175]
  v_mfma_f32_16x16x32_bf16 v[176:179], v[32:35], v[48:51], v[176:179]
  v_mfma_f32_16x16x32_bf16 v[180:183], v[32:35], v[52:55], v[180:183]
  v_mfma_f32_16x16x32_bf16 v[184:187], v[32:35], v[56:59], v[184:187]
  v_mfma_f32_16x16x32_bf16 v[188:191], v[32:35], v[60:63], v[188:191]
  v_mfma_f32_16x16x32_bf16 v[192:195], v[36:39], v[48:51], v[192:195]
  v_mfma_f32_16x16x32_bf16 v[196:199], v[36:39], v[52:55], v[196:199]
  v_mfma_f32_16x16x32_bf16 v[200:203], v[36:39], v[56:59], v[200:203]
  v_mfma_f32_16x16x32_bf16 v[204:207], v[36:39], v[60:63], v[204:207]
  v_mfma_f32_16x16x32_bf16 v[208:211], v[40:43], v[48:51], v[208:211]
  v_mfma_f32_16x16x32_bf16 v[212:215], v[40:43], v[52:55], v[212:215]
  v_mfma_f32_16x16x32_bf16 v[216:219], v[40:43], v[56:59], v[216:219]
  v_mfma_f32_16x16x32_bf16 v[220:223], v[40:43], v[60:63], v[220:223]
  v_mfma_f32_16x16x32_bf16 v[224:227], v[44:47], v[48:51], v[224:227]
  v_mfma_f32_16x16x32_bf16 v[228:231], v[44:47], v[52:55], v[228:231]
  v_mfma_f32_16x16x32_bf16 v[232:235], v[44:47], v[56:59], v[232:235]
  v_mfma_f32_16x16x32_bf16 v[236:239], v[44:47], v[60:63], v[236:239]
  s_waitcnt lgkmcnt(0)
  v_mfma_f32_16x16x32_bf16 v[112:115], v[64:67], v[96:99], v[112:115]
  v_mfma_f32_16x16x32_bf16 v[116:119], v[64:67], v[100:103], v[116:119]
  v_mfma_f32_16x16x32_bf16 v[120:123], v[64:67], v[104:107], v[120:123]
  v_mfma_f32_16x16x32_bf16 v[124:127], v[64:67], v[108:111], v[124:127]
  v_mfma_f32_16x16x32_bf16 v[128:131], v[68:71], v[96:99], v[128:131]
  v_mfma_f32_16x16x32_bf16 v[132:135], v[68:71], v[100:103], v[132:135]
  v_mfma_f32_16x16x32_bf16 v[136:139], v[68:71], v[104:107], v[136:139]
  v_mfma_f32_16x16x32_bf16 v[140:143], v[68:71], v[108:111], v[140:143]
  v_mfma_f32_16x16x32_bf16 v[144:147], v[72:75], v[96:99], v[144:147]
  v_mfma_f32_16x16x32_bf16 v[148:151], v[72:75], v[100:103], v[148:151]
  v_mfma_f32_16x16x32_bf16 v[152:155], v[72:75], v[104:107], v[152:155]
  v_mfma_f32_16x16x32_bf16 v[156:159], v[72:75], v[108:111], v[156:159]
  v_mfma_f32_16x16x32_bf16 v[160:163], v[76:79], v[96:99], v[160:163]
  v_mfma_f32_16x16x32_bf16 v[164:167], v[76:79], v[100:103], v[164:167]
  v_mfma_f32_16x16x32_bf16 v[168:171], v[76:79], v[104:107], v[168:171]
  v_mfma_f32_16x16x32_bf16 v[172:175], v[76:79], v[108:111], v[172:175]
  v_mfma_f32_16x16x32_bf16 v[176:179], v[80:83], v[96:99], v[176:179]
  v_mfma_f32_16x16x32_bf16 v[180:183], v[80:83], v[100:103], v[180:183]
  v_mfma_f32_16x16x32_bf16 v[184:187], v[80:83], v[104:107], v[184:187]
  v_mfma_f32_16x16x32_bf16 v[188:191], v[80:83], v[108:111], v[188:191]
  v_mfma_f32_16x16x32_bf16 v[192:195], v[84:87], v[96:99], v[192:195]
  v_mfma_f32_16x16x32_bf16 v[196:199], v[84:87], v[100:103], v[196:199]
  v_mfma_f32_16x16x32_bf16 v[200:203], v[84:87], v[104:107], v[200:203]
  v_mfma_f32_16x16x32_bf16 v[204:207], v[84:87], v[108:111], v[204:207]
  v_mfma_f32_16x16x32_bf16 v[208:211], v[88:91], v[96:99], v[208:211]
  v_mfma_f32_16x16x32_bf16 v[212:215], v[88:91], v[100:103], v[212:215]
  v_mfma_f32_16x16x32_bf16 v[216:219], v[88:91], v[104:107], v[216:219]
  v_mfma_f32_16x16x32_bf16 v[220:223], v[88:91], v[108:111], v[220:223]
  v_mfma_f32_16x16x32_bf16 v[224:227], v[92:95], v[96:99], v[224:227]
  v_mfma_f32_16x16x32_bf16 v[228:231], v[92:95], v[100:103], v[228:231]
  v_mfma_f32_16x16x32_bf16 v[232:235], v[92:95], v[104:107], v[232:235]
  v_mfma_f32_16x16x32_bf16 v[236:239], v[92:95], v[108:111], v[236:239]
  s_mov_b32 s36, s92
  s_mov_b32 s37, s93
  s_mov_b32 s38, 4096
  s_mov_b32 s39, 0x20000
  s_lshl_b32 s23, s28, 6
  s_add_u32 s23, s23, s18
  v_and_b32 v244, 15, v0
  v_add_u32 v244, s23, v244
  v_lshlrev_b32 v244, 1, v244
  buffer_load_ushort v240, v244, s[36:39], 0 offen offset:0
  buffer_load_ushort v241, v244, s[36:39], 0 offen offset:32
  buffer_load_ushort v242, v244, s[36:39], 0 offen offset:64
  buffer_load_ushort v243, v244, s[36:39], 0 offen offset:96
  s_mov_b32 s44, 3222493025
  s_mov_b32 s45, 3222493025
  s_mov_b32 s46, 3184710632
  s_mov_b32 s47, 3184710632
  v_mov_b32 v56, s44
  v_mov_b32 v57, s45
  v_mov_b32 v64, 0
  v_mov_b32 v65, 0
  v_mov_b32 v66, 0
  v_mov_b32 v67, 0
  v_mov_b32 v68, 0
  v_mov_b32 v69, 0
  v_mov_b32 v70, 0
  v_mov_b32 v71, 0
  v_mov_b32 v72, 0
  v_mov_b32 v73, 0
  v_mov_b32 v74, 0
  v_mov_b32 v75, 0
  v_mov_b32 v76, 0
  v_mov_b32 v77, 0
  v_mov_b32 v78, 0
  v_mov_b32 v79, 0
  s_nop 3
  v_pk_mul_f32 v[48:49], v[176:177], v[176:177]
  v_pk_mul_f32 v[50:51], v[178:179], v[178:179]
  v_pk_mul_f32 v[58:59], v[192:193], v[192:193]
  v_pk_mul_f32 v[60:61], v[194:195], v[194:195]
  v_pk_fma_f32 v[48:49], v[48:49], s[46:47], v[56:57]
  v_pk_fma_f32 v[50:51], v[50:51], s[46:47], v[56:57]
  v_pk_fma_f32 v[58:59], v[58:59], s[46:47], v[56:57]
  v_pk_fma_f32 v[60:61], v[60:61], s[46:47], v[56:57]
  v_pk_mul_f32 v[48:49], v[48:49], v[176:177]
  v_pk_mul_f32 v[50:51], v[50:51], v[178:179]
  v_pk_mul_f32 v[58:59], v[58:59], v[192:193]
  v_pk_mul_f32 v[60:61], v[60:61], v[194:195]
  v_exp_f32 v48, v48
  v_exp_f32 v49, v49
  v_exp_f32 v50, v50
  v_exp_f32 v51, v51
  v_exp_f32 v58, v58
  v_exp_f32 v59, v59
  v_exp_f32 v60, v60
  v_exp_f32 v61, v61
  v_pk_add_f32 v[48:49], v[48:49], 1.0 op_sel_hi:[1,0]
  v_pk_add_f32 v[50:51], v[50:51], 1.0 op_sel_hi:[1,0]
  v_rcp_f32 v48, v48
  v_rcp_f32 v49, v49
  v_rcp_f32 v50, v50
  v_rcp_f32 v51, v51
  v_pk_add_f32 v[58:59], v[58:59], 1.0 op_sel_hi:[1,0]
  v_pk_add_f32 v[60:61], v[60:61], 1.0 op_sel_hi:[1,0]
  v_rcp_f32 v58, v58
  v_rcp_f32 v59, v59
  v_rcp_f32 v60, v60
  v_rcp_f32 v61, v61
  v_pk_mul_f32 v[176:177], v[176:177], v[48:49]
  v_pk_mul_f32 v[178:179], v[178:179], v[50:51]
  v_pk_mul_f32 v[192:193], v[192:193], v[58:59]
  v_pk_mul_f32 v[194:195], v[194:195], v[60:61]
  v_pk_add_f32 v[64:65], v[64:65], v[176:177]
  v_pk_fma_f32 v[72:73], v[176:177], v[176:177], v[72:73]
  v_pk_add_f32 v[64:65], v[64:65], v[178:179]
  v_pk_fma_f32 v[72:73], v[178:179], v[178:179], v[72:73]
  v_pk_add_f32 v[64:65], v[64:65], v[192:193]
  v_pk_fma_f32 v[72:73], v[192:193], v[192:193], v[72:73]
  v_pk_add_f32 v[64:65], v[64:65], v[194:195]
  v_pk_fma_f32 v[72:73], v[194:195], v[194:195], v[72:73]
  v_pk_mul_f32 v[48:49], v[208:209], v[208:209]
  v_pk_mul_f32 v[50:51], v[210:211], v[210:211]
  v_pk_mul_f32 v[58:59], v[224:225], v[224:225]
  v_pk_mul_f32 v[60:61], v[226:227], v[226:227]
  v_pk_fma_f32 v[48:49], v[48:49], s[46:47], v[56:57]
  v_pk_fma_f32 v[50:51], v[50:51], s[46:47], v[56:57]
  v_pk_fma_f32 v[58:59], v[58:59], s[46:47], v[56:57]
  v_pk_fma_f32 v[60:61], v[60:61], s[46:47], v[56:57]
  v_pk_mul_f32 v[48:49], v[48:49], v[208:209]
  v_pk_mul_f32 v[50:51], v[50:51], v[210:211]
  v_pk_mul_f32 v[58:59], v[58:59], v[224:225]
  v_pk_mul_f32 v[60:61], v[60:61], v[226:227]
  v_exp_f32 v48, v48
  v_exp_f32 v49, v49
  v_exp_f32 v50, v50
  v_exp_f32 v51, v51
  v_exp_f32 v58, v58
  v_exp_f32 v59, v59
  v_exp_f32 v60, v60
  v_exp_f32 v61, v61
  v_pk_add_f32 v[48:49], v[48:49], 1.0 op_sel_hi:[1,0]
  v_pk_add_f32 v[50:51], v[50:51], 1.0 op_sel_hi:[1,0]
  v_rcp_f32 v48, v48
  v_rcp_f32 v49, v49
  v_rcp_f32 v50, v50
  v_rcp_f32 v51, v51
  v_pk_add_f32 v[58:59], v[58:59], 1.0 op_sel_hi:[1,0]
  v_pk_add_f32 v[60:61], v[60:61], 1.0 op_sel_hi:[1,0]
  v_rcp_f32 v58, v58
  v_rcp_f32 v59, v59
  v_rcp_f32 v60, v60
  v_rcp_f32 v61, v61
  v_pk_mul_f32 v[208:209], v[208:209], v[48:49]
  v_pk_mul_f32 v[210:211], v[210:211], v[50:51]
  v_pk_mul_f32 v[224:225], v[224:225], v[58:59]
  v_pk_mul_f32 v[226:227], v[226:227], v[60:61]
  v_pk_add_f32 v[64:65], v[64:65], v[208:209]
  v_pk_fma_f32 v[72:73], v[208:209], v[208:209], v[72:73]
  v_pk_add_f32 v[64:65], v[64:65], v[210:211]
  v_pk_fma_f32 v[72:73], v[210:211], v[210:211], v[72:73]
  v_pk_add_f32 v[64:65], v[64:65], v[224:225]
  v_pk_fma_f32 v[72:73], v[224:225], v[224:225], v[72:73]
  v_pk_add_f32 v[64:65], v[64:65], v[226:227]
  v_pk_fma_f32 v[72:73], v[226:227], v[226:227], v[72:73]
  v_pk_mul_f32 v[48:49], v[180:181], v[180:181]
  v_pk_mul_f32 v[50:51], v[182:183], v[182:183]
  v_pk_mul_f32 v[58:59], v[196:197], v[196:197]
  v_pk_mul_f32 v[60:61], v[198:199], v[198:199]
  v_pk_fma_f32 v[48:49], v[48:49], s[46:47], v[56:57]
  v_pk_fma_f32 v[50:51], v[50:51], s[46:47], v[56:57]
  v_pk_fma_f32 v[58:59], v[58:59], s[46:47], v[56:57]
  v_pk_fma_f32 v[60:61], v[60:61], s[46:47], v[56:57]
  v_pk_mul_f32 v[48:49], v[48:49], v[180:181]
  v_pk_mul_f32 v[50:51], v[50:51], v[182:183]
  v_pk_mul_f32 v[58:59], v[58:59], v[196:197]
  v_pk_mul_f32 v[60:61], v[60:61], v[198:199]
  v_exp_f32 v48, v48
  v_exp_f32 v49, v49
  v_exp_f32 v50, v50
  v_exp_f32 v51, v51
  v_exp_f32 v58, v58
  v_exp_f32 v59, v59
  v_exp_f32 v60, v60
  v_exp_f32 v61, v61
  v_pk_add_f32 v[48:49], v[48:49], 1.0 op_sel_hi:[1,0]
  v_pk_add_f32 v[50:51], v[50:51], 1.0 op_sel_hi:[1,0]
  v_rcp_f32 v48, v48
  v_rcp_f32 v49, v49
  v_rcp_f32 v50, v50
  v_rcp_f32 v51, v51
  v_pk_add_f32 v[58:59], v[58:59], 1.0 op_sel_hi:[1,0]
  v_pk_add_f32 v[60:61], v[60:61], 1.0 op_sel_hi:[1,0]
  v_rcp_f32 v58, v58
  v_rcp_f32 v59, v59
  v_rcp_f32 v60, v60
  v_rcp_f32 v61, v61
  v_pk_mul_f32 v[180:181], v[180:181], v[48:49]
  v_pk_mul_f32 v[182:183], v[182:183], v[50:51]
  v_pk_mul_f32 v[196:197], v[196:197], v[58:59]
  v_pk_mul_f32 v[198:199], v[198:199], v[60:61]
  v_pk_add_f32 v[66:67], v[66:67], v[180:181]
  v_pk_fma_f32 v[74:75], v[180:181], v[180:181], v[74:75]
  v_pk_add_f32 v[66:67], v[66:67], v[182:183]
  v_pk_fma_f32 v[74:75], v[182:183], v[182:183], v[74:75]
  v_pk_add_f32 v[66:67], v[66:67], v[196:197]
  v_pk_fma_f32 v[74:75], v[196:197], v[196:197], v[74:75]
  v_pk_add_f32 v[66:67], v[66:67], v[198:199]
  v_pk_fma_f32 v[74:75], v[198:199], v[198:199], v[74:75]
  v_pk_mul_f32 v[48:49], v[212:213], v[212:213]
  v_pk_mul_f32 v[50:51], v[214:215], v[214:215]
  v_pk_mul_f32 v[58:59], v[228:229], v[228:229]
  v_pk_mul_f32 v[60:61], v[230:231], v[230:231]
  v_pk_fma_f32 v[48:49], v[48:49], s[46:47], v[56:57]
  v_pk_fma_f32 v[50:51], v[50:51], s[46:47], v[56:57]
  v_pk_fma_f32 v[58:59], v[58:59], s[46:47], v[56:57]
  v_pk_fma_f32 v[60:61], v[60:61], s[46:47], v[56:57]
  v_pk_mul_f32 v[48:49], v[48:49], v[212:213]
  v_pk_mul_f32 v[50:51], v[50:51], v[214:215]
  v_pk_mul_f32 v[58:59], v[58:59], v[228:229]
  v_pk_mul_f32 v[60:61], v[60:61], v[230:231]
  v_exp_f32 v48, v48
  v_exp_f32 v49, v49
  v_exp_f32 v50, v50
  v_exp_f32 v51, v51
  v_exp_f32 v58, v58
  v_exp_f32 v59, v59
  v_exp_f32 v60, v60
  v_exp_f32 v61, v61
  v_pk_add_f32 v[48:49], v[48:49], 1.0 op_sel_hi:[1,0]
  v_pk_add_f32 v[50:51], v[50:51], 1.0 op_sel_hi:[1,0]
  v_rcp_f32 v48, v48
  v_rcp_f32 v49, v49
  v_rcp_f32 v50, v50
  v_rcp_f32 v51, v51
  v_pk_add_f32 v[58:59], v[58:59], 1.0 op_sel_hi:[1,0]
  v_pk_add_f32 v[60:61], v[60:61], 1.0 op_sel_hi:[1,0]
  v_rcp_f32 v58, v58
  v_rcp_f32 v59, v59
  v_rcp_f32 v60, v60
  v_rcp_f32 v61, v61
  v_pk_mul_f32 v[212:213], v[212:213], v[48:49]
  v_pk_mul_f32 v[214:215], v[214:215], v[50:51]
  v_pk_mul_f32 v[228:229], v[228:229], v[58:59]
  v_pk_mul_f32 v[230:231], v[230:231], v[60:61]
  v_pk_add_f32 v[66:67], v[66:67], v[212:213]
  v_pk_fma_f32 v[74:75], v[212:213], v[212:213], v[74:75]
  v_pk_add_f32 v[66:67], v[66:67], v[214:215]
  v_pk_fma_f32 v[74:75], v[214:215], v[214:215], v[74:75]
  v_pk_add_f32 v[66:67], v[66:67], v[228:229]
  v_pk_fma_f32 v[74:75], v[228:229], v[228:229], v[74:75]
  v_pk_add_f32 v[66:67], v[66:67], v[230:231]
  v_pk_fma_f32 v[74:75], v[230:231], v[230:231], v[74:75]
  v_pk_mul_f32 v[48:49], v[184:185], v[184:185]
  v_pk_mul_f32 v[50:51], v[186:187], v[186:187]
  v_pk_mul_f32 v[58:59], v[200:201], v[200:201]
  v_pk_mul_f32 v[60:61], v[202:203], v[202:203]
  v_pk_fma_f32 v[48:49], v[48:49], s[46:47], v[56:57]
  v_pk_fma_f32 v[50:51], v[50:51], s[46:47], v[56:57]
  v_pk_fma_f32 v[58:59], v[58:59], s[46:47], v[56:57]
  v_pk_fma_f32 v[60:61], v[60:61], s[46:47], v[56:57]
  v_pk_mul_f32 v[48:49], v[48:49], v[184:185]
  v_pk_mul_f32 v[50:51], v[50:51], v[186:187]
  v_pk_mul_f32 v[58:59], v[58:59], v[200:201]
  v_pk_mul_f32 v[60:61], v[60:61], v[202:203]
  v_exp_f32 v48, v48
  v_exp_f32 v49, v49
  v_exp_f32 v50, v50
  v_exp_f32 v51, v51
  v_exp_f32 v58, v58
  v_exp_f32 v59, v59
  v_exp_f32 v60, v60
  v_exp_f32 v61, v61
  v_pk_add_f32 v[48:49], v[48:49], 1.0 op_sel_hi:[1,0]
  v_pk_add_f32 v[50:51], v[50:51], 1.0 op_sel_hi:[1,0]
  v_rcp_f32 v48, v48
  v_rcp_f32 v49, v49
  v_rcp_f32 v50, v50
  v_rcp_f32 v51, v51
  v_pk_add_f32 v[58:59], v[58:59], 1.0 op_sel_hi:[1,0]
  v_pk_add_f32 v[60:61], v[60:61], 1.0 op_sel_hi:[1,0]
  v_rcp_f32 v58, v58
  v_rcp_f32 v59, v59
  v_rcp_f32 v60, v60
  v_rcp_f32 v61, v61
  v_pk_mul_f32 v[184:185], v[184:185], v[48:49]
  v_pk_mul_f32 v[186:187], v[186:187], v[50:51]
  v_pk_mul_f32 v[200:201], v[200:201], v[58:59]
  v_pk_mul_f32 v[202:203], v[202:203], v[60:61]
  v_pk_add_f32 v[68:69], v[68:69], v[184:185]
  v_pk_fma_f32 v[76:77], v[184:185], v[184:185], v[76:77]
  v_pk_add_f32 v[68:69], v[68:69], v[186:187]
  v_pk_fma_f32 v[76:77], v[186:187], v[186:187], v[76:77]
  v_pk_add_f32 v[68:69], v[68:69], v[200:201]
  v_pk_fma_f32 v[76:77], v[200:201], v[200:201], v[76:77]
  v_pk_add_f32 v[68:69], v[68:69], v[202:203]
  v_pk_fma_f32 v[76:77], v[202:203], v[202:203], v[76:77]
  v_pk_mul_f32 v[48:49], v[216:217], v[216:217]
  v_pk_mul_f32 v[50:51], v[218:219], v[218:219]
  v_pk_mul_f32 v[58:59], v[232:233], v[232:233]
  v_pk_mul_f32 v[60:61], v[234:235], v[234:235]
  v_pk_fma_f32 v[48:49], v[48:49], s[46:47], v[56:57]
  v_pk_fma_f32 v[50:51], v[50:51], s[46:47], v[56:57]
  v_pk_fma_f32 v[58:59], v[58:59], s[46:47], v[56:57]
  v_pk_fma_f32 v[60:61], v[60:61], s[46:47], v[56:57]
  v_pk_mul_f32 v[48:49], v[48:49], v[216:217]
  v_pk_mul_f32 v[50:51], v[50:51], v[218:219]
  v_pk_mul_f32 v[58:59], v[58:59], v[232:233]
  v_pk_mul_f32 v[60:61], v[60:61], v[234:235]
  v_exp_f32 v48, v48
  v_exp_f32 v49, v49
  v_exp_f32 v50, v50
  v_exp_f32 v51, v51
  v_exp_f32 v58, v58
  v_exp_f32 v59, v59
  v_exp_f32 v60, v60
  v_exp_f32 v61, v61
  v_pk_add_f32 v[48:49], v[48:49], 1.0 op_sel_hi:[1,0]
  v_pk_add_f32 v[50:51], v[50:51], 1.0 op_sel_hi:[1,0]
  v_rcp_f32 v48, v48
  v_rcp_f32 v49, v49
  v_rcp_f32 v50, v50
  v_rcp_f32 v51, v51
  v_pk_add_f32 v[58:59], v[58:59], 1.0 op_sel_hi:[1,0]
  v_pk_add_f32 v[60:61], v[60:61], 1.0 op_sel_hi:[1,0]
  v_rcp_f32 v58, v58
  v_rcp_f32 v59, v59
  v_rcp_f32 v60, v60
  v_rcp_f32 v61, v61
  v_pk_mul_f32 v[216:217], v[216:217], v[48:49]
  v_pk_mul_f32 v[218:219], v[218:219], v[50:51]
  v_pk_mul_f32 v[232:233], v[232:233], v[58:59]
  v_pk_mul_f32 v[234:235], v[234:235], v[60:61]
  v_pk_add_f32 v[68:69], v[68:69], v[216:217]
  v_pk_fma_f32 v[76:77], v[216:217], v[216:217], v[76:77]
  v_pk_add_f32 v[68:69], v[68:69], v[218:219]
  v_pk_fma_f32 v[76:77], v[218:219], v[218:219], v[76:77]
  v_pk_add_f32 v[68:69], v[68:69], v[232:233]
  v_pk_fma_f32 v[76:77], v[232:233], v[232:233], v[76:77]
  v_pk_add_f32 v[68:69], v[68:69], v[234:235]
  v_pk_fma_f32 v[76:77], v[234:235], v[234:235], v[76:77]
  v_pk_mul_f32 v[48:49], v[188:189], v[188:189]
  v_pk_mul_f32 v[50:51], v[190:191], v[190:191]
  v_pk_mul_f32 v[58:59], v[204:205], v[204:205]
  v_pk_mul_f32 v[60:61], v[206:207], v[206:207]
  v_pk_fma_f32 v[48:49], v[48:49], s[46:47], v[56:57]
  v_pk_fma_f32 v[50:51], v[50:51], s[46:47], v[56:57]
  v_pk_fma_f32 v[58:59], v[58:59], s[46:47], v[56:57]
  v_pk_fma_f32 v[60:61], v[60:61], s[46:47], v[56:57]
  v_pk_mul_f32 v[48:49], v[48:49], v[188:189]
  v_pk_mul_f32 v[50:51], v[50:51], v[190:191]
  v_pk_mul_f32 v[58:59], v[58:59], v[204:205]
  v_pk_mul_f32 v[60:61], v[60:61], v[206:207]
  v_exp_f32 v48, v48
  v_exp_f32 v49, v49
  v_exp_f32 v50, v50
  v_exp_f32 v51, v51
  v_exp_f32 v58, v58
  v_exp_f32 v59, v59
  v_exp_f32 v60, v60
  v_exp_f32 v61, v61
  v_pk_add_f32 v[48:49], v[48:49], 1.0 op_sel_hi:[1,0]
  v_pk_add_f32 v[50:51], v[50:51], 1.0 op_sel_hi:[1,0]
  v_rcp_f32 v48, v48
  v_rcp_f32 v49, v49
  v_rcp_f32 v50, v50
  v_rcp_f32 v51, v51
  v_pk_add_f32 v[58:59], v[58:59], 1.0 op_sel_hi:[1,0]
  v_pk_add_f32 v[60:61], v[60:61], 1.0 op_sel_hi:[1,0]
  v_rcp_f32 v58, v58
  v_rcp_f32 v59, v59
  v_rcp_f32 v60, v60
  v_rcp_f32 v61, v61
  v_pk_mul_f32 v[188:189], v[188:189], v[48:49]
  v_pk_mul_f32 v[190:191], v[190:191], v[50:51]
  v_pk_mul_f32 v[204:205], v[204:205], v[58:59]
  v_pk_mul_f32 v[206:207], v[206:207], v[60:61]
  v_pk_add_f32 v[70:71], v[70:71], v[188:189]
  v_pk_fma_f32 v[78:79], v[188:189], v[188:189], v[78:79]
  v_pk_add_f32 v[70:71], v[70:71], v[190:191]
  v_pk_fma_f32 v[78:79], v[190:191], v[190:191], v[78:79]
  v_pk_add_f32 v[70:71], v[70:71], v[204:205]
  v_pk_fma_f32 v[78:79], v[204:205], v[204:205], v[78:79]
  v_pk_add_f32 v[70:71], v[70:71], v[206:207]
  v_pk_fma_f32 v[78:79], v[206:207], v[206:207], v[78:79]
  v_pk_mul_f32 v[48:49], v[220:221], v[220:221]
  v_pk_mul_f32 v[50:51], v[222:223], v[222:223]
  v_pk_mul_f32 v[58:59], v[236:237], v[236:237]
  v_pk_mul_f32 v[60:61], v[238:239], v[238:239]
  v_pk_fma_f32 v[48:49], v[48:49], s[46:47], v[56:57]
  v_pk_fma_f32 v[50:51], v[50:51], s[46:47], v[56:57]
  v_pk_fma_f32 v[58:59], v[58:59], s[46:47], v[56:57]
  v_pk_fma_f32 v[60:61], v[60:61], s[46:47], v[56:57]
  v_pk_mul_f32 v[48:49], v[48:49], v[220:221]
  v_pk_mul_f32 v[50:51], v[50:51], v[222:223]
  v_pk_mul_f32 v[58:59], v[58:59], v[236:237]
  v_pk_mul_f32 v[60:61], v[60:61], v[238:239]
  v_exp_f32 v48, v48
  v_exp_f32 v49, v49
  v_exp_f32 v50, v50
  v_exp_f32 v51, v51
  v_exp_f32 v58, v58
  v_exp_f32 v59, v59
  v_exp_f32 v60, v60
  v_exp_f32 v61, v61
  v_pk_add_f32 v[48:49], v[48:49], 1.0 op_sel_hi:[1,0]
  v_pk_add_f32 v[50:51], v[50:51], 1.0 op_sel_hi:[1,0]
  v_rcp_f32 v48, v48
  v_rcp_f32 v49, v49
  v_rcp_f32 v50, v50
  v_rcp_f32 v51, v51
  v_pk_add_f32 v[58:59], v[58:59], 1.0 op_sel_hi:[1,0]
  v_pk_add_f32 v[60:61], v[60:61], 1.0 op_sel_hi:[1,0]
  v_rcp_f32 v58, v58
  v_rcp_f32 v59, v59
  v_rcp_f32 v60, v60
  v_rcp_f32 v61, v61
  v_pk_mul_f32 v[220:221], v[220:221], v[48:49]
  v_pk_mul_f32 v[222:223], v[222:223], v[50:51]
  v_pk_mul_f32 v[236:237], v[236:237], v[58:59]
  v_pk_mul_f32 v[238:239], v[238:239], v[60:61]
  v_pk_add_f32 v[70:71], v[70:71], v[220:221]
  v_pk_fma_f32 v[78:79], v[220:221], v[220:221], v[78:79]
  v_pk_add_f32 v[70:71], v[70:71], v[222:223]
  v_pk_fma_f32 v[78:79], v[222:223], v[222:223], v[78:79]
  v_pk_add_f32 v[70:71], v[70:71], v[236:237]
  v_pk_fma_f32 v[78:79], v[236:237], v[236:237], v[78:79]
  v_pk_add_f32 v[70:71], v[70:71], v[238:239]
  v_pk_fma_f32 v[78:79], v[238:239], v[238:239], v[78:79]
  v_add_f32 v80, v64, v65
  v_add_f32 v84, v72, v73
  v_add_f32 v81, v66, v67
  v_add_f32 v85, v74, v75
  v_add_f32 v82, v68, v69
  v_add_f32 v86, v76, v77
  v_add_f32 v83, v70, v71
  v_add_f32 v87, v78, v79
  v_mov_b32 v88, v80
  v_mov_b32 v89, v81
  v_mov_b32 v90, v82
  v_mov_b32 v91, v83
  v_mov_b32 v92, v84
  v_mov_b32 v93, v85
  v_mov_b32 v94, v86
  v_mov_b32 v95, v87
  s_nop 1
  v_permlane16_swap_b32 v80, v88
  v_permlane16_swap_b32 v81, v89
  v_permlane16_swap_b32 v82, v90
  v_permlane16_swap_b32 v83, v91
  v_permlane16_swap_b32 v84, v92
  v_permlane16_swap_b32 v85, v93
  v_permlane16_swap_b32 v86, v94
  v_permlane16_swap_b32 v87, v95
  v_add_f32 v80, v80, v88
  v_add_f32 v81, v81, v89
  v_add_f32 v82, v82, v90
  v_add_f32 v83, v83, v91
  v_add_f32 v84, v84, v92
  v_add_f32 v85, v85, v93
  v_add_f32 v86, v86, v94
  v_add_f32 v87, v87, v95
  v_mov_b32 v88, v80
  v_mov_b32 v89, v81
  v_mov_b32 v90, v82
  v_mov_b32 v91, v83
  v_mov_b32 v92, v84
  v_mov_b32 v93, v85
  v_mov_b32 v94, v86
  v_mov_b32 v95, v87
  s_nop 1
  v_permlane32_swap_b32 v80, v88
  v_permlane32_swap_b32 v81, v89
  v_permlane32_swap_b32 v82, v90
  v_permlane32_swap_b32 v83, v91
  v_permlane32_swap_b32 v84, v92
  v_permlane32_swap_b32 v85, v93
  v_permlane32_swap_b32 v86, v94
  v_permlane32_swap_b32 v87, v95
  v_add_f32 v80, v80, v88
  v_add_f32 v81, v81, v89
  v_add_f32 v82, v82, v90
  v_add_f32 v83, v83, v91
  v_add_f32 v84, v84, v92
  v_add_f32 v85, v85, v93
  v_add_f32 v86, v86, v94
  v_add_f32 v87, v87, v95
  v_cmp_le_u32 vcc, 16, v0
  s_nop 1
  v_cndmask_b32 v88, v80, v82, vcc
  v_cndmask_b32 v89, v84, v86, vcc
  v_cndmask_b32 v90, v81, v83, vcc
  v_cndmask_b32 v91, v85, v87, vcc
  s_add_u32 s36, s30, 67108864
  s_addc_u32 s37, s31, 0
  s_mov_b32 s38, 524288
  s_mov_b32 s39, 0x20000
  s_lshl_b32 s23, s40, 1
  s_add_u32 s23, s23, s28
  s_mul_i32 s23, s23, 14336
  s_lshl_b32 s24, s41, 1
  s_add_u32 s24, s24, s27
  s_lshl_b32 s24, s24, 9
  s_add_u32 s24, s24, s23
  v_lshlrev_b32 v1, 4, v0
  s_mov_b32 exec_hi, 0
  buffer_store_dwordx4 v[88:91], v1, s[36:39], s24 offen sc1
  s_mov_b32 exec_hi, -1
  v_and_b32 v1, 15, v0
  v_lshlrev_b32 v1, 4, v1
  v_bfe_u32 v2, v0, 4, 1
  v_lshl_add_u32 v1, v2, 3, v1
  v_lshrrev_b32 v2, 5, v0
  v_lshl_add_u32 v1, v2, 8, v1
  v_pk_mul_f32 v[48:49], v[112:113], v[112:113]
  v_pk_mul_f32 v[50:51], v[114:115], v[114:115]
  v_pk_mul_f32 v[58:59], v[128:129], v[128:129]
  v_pk_mul_f32 v[60:61], v[130:131], v[130:131]
  v_pk_fma_f32 v[48:49], v[48:49], s[46:47], v[56:57]
  v_pk_fma_f32 v[50:51], v[50:51], s[46:47], v[56:57]
  v_pk_fma_f32 v[58:59], v[58:59], s[46:47], v[56:57]
  v_pk_fma_f32 v[60:61], v[60:61], s[46:47], v[56:57]
  v_pk_mul_f32 v[48:49], v[48:49], v[112:113]
  v_pk_mul_f32 v[50:51], v[50:51], v[114:115]
  v_pk_mul_f32 v[58:59], v[58:59], v[128:129]
  v_pk_mul_f32 v[60:61], v[60:61], v[130:131]
  v_exp_f32 v48, v48
  v_exp_f32 v49, v49
  v_exp_f32 v50, v50
  v_exp_f32 v51, v51
  v_exp_f32 v58, v58
  v_exp_f32 v59, v59
  v_exp_f32 v60, v60
  v_exp_f32 v61, v61
  v_pk_add_f32 v[48:49], v[48:49], 1.0 op_sel_hi:[1,0]
  v_pk_add_f32 v[50:51], v[50:51], 1.0 op_sel_hi:[1,0]
  v_rcp_f32 v48, v48
  v_rcp_f32 v49, v49
  v_rcp_f32 v50, v50
  v_rcp_f32 v51, v51
  v_pk_add_f32 v[58:59], v[58:59], 1.0 op_sel_hi:[1,0]
  v_pk_add_f32 v[60:61], v[60:61], 1.0 op_sel_hi:[1,0]
  v_rcp_f32 v58, v58
  v_rcp_f32 v59, v59
  v_rcp_f32 v60, v60
  v_rcp_f32 v61, v61
  v_pk_mul_f32 v[112:113], v[112:113], v[48:49]
  v_pk_mul_f32 v[114:115], v[114:115], v[50:51]
  v_pk_mul_f32 v[128:129], v[128:129], v[58:59]
  v_pk_mul_f32 v[130:131], v[130:131], v[60:61]
  v_cvt_pk_bf16_f32 v16, v112, v113
  v_cvt_pk_bf16_f32 v17, v114, v115
  v_cvt_pk_bf16_f32 v18, v128, v129
  v_cvt_pk_bf16_f32 v19, v130, v131
  v_pk_mul_f32 v[48:49], v[144:145], v[144:145]
  v_pk_mul_f32 v[50:51], v[146:147], v[146:147]
  v_pk_mul_f32 v[58:59], v[160:161], v[160:161]
  v_pk_mul_f32 v[60:61], v[162:163], v[162:163]
  v_pk_fma_f32 v[48:49], v[48:49], s[46:47], v[56:57]
  v_pk_fma_f32 v[50:51], v[50:51], s[46:47], v[56:57]
  v_pk_fma_f32 v[58:59], v[58:59], s[46:47], v[56:57]
  v_pk_fma_f32 v[60:61], v[60:61], s[46:47], v[56:57]
  v_pk_mul_f32 v[48:49], v[48:49], v[144:145]
  v_pk_mul_f32 v[50:51], v[50:51], v[146:147]
  v_pk_mul_f32 v[58:59], v[58:59], v[160:161]
  v_pk_mul_f32 v[60:61], v[60:61], v[162:163]
  v_exp_f32 v48, v48
  v_exp_f32 v49, v49
  v_exp_f32 v50, v50
  v_exp_f32 v51, v51
  v_exp_f32 v58, v58
  v_exp_f32 v59, v59
  v_exp_f32 v60, v60
  v_exp_f32 v61, v61
  v_pk_add_f32 v[48:49], v[48:49], 1.0 op_sel_hi:[1,0]
  v_pk_add_f32 v[50:51], v[50:51], 1.0 op_sel_hi:[1,0]
  v_rcp_f32 v48, v48
  v_rcp_f32 v49, v49
  v_rcp_f32 v50, v50
  v_rcp_f32 v51, v51
  v_pk_add_f32 v[58:59], v[58:59], 1.0 op_sel_hi:[1,0]
  v_pk_add_f32 v[60:61], v[60:61], 1.0 op_sel_hi:[1,0]
  v_rcp_f32 v58, v58
  v_rcp_f32 v59, v59
  v_rcp_f32 v60, v60
  v_rcp_f32 v61, v61
  v_pk_mul_f32 v[144:145], v[144:145], v[48:49]
  v_pk_mul_f32 v[146:147], v[146:147], v[50:51]
  v_pk_mul_f32 v[160:161], v[160:161], v[58:59]
  v_pk_mul_f32 v[162:163], v[162:163], v[60:61]
  v_cvt_pk_bf16_f32 v20, v144, v145
  v_cvt_pk_bf16_f32 v21, v146, v147
  v_cvt_pk_bf16_f32 v22, v160, v161
  v_cvt_pk_bf16_f32 v23, v162, v163
  v_pk_mul_f32 v[48:49], v[116:117], v[116:117]
  v_pk_mul_f32 v[50:51], v[118:119], v[118:119]
  v_pk_mul_f32 v[58:59], v[132:133], v[132:133]
  v_pk_mul_f32 v[60:61], v[134:135], v[134:135]
  v_pk_fma_f32 v[48:49], v[48:49], s[46:47], v[56:57]
  v_pk_fma_f32 v[50:51], v[50:51], s[46:47], v[56:57]
  v_pk_fma_f32 v[58:59], v[58:59], s[46:47], v[56:57]
  v_pk_fma_f32 v[60:61], v[60:61], s[46:47], v[56:57]
  v_pk_mul_f32 v[48:49], v[48:49], v[116:117]
  v_pk_mul_f32 v[50:51], v[50:51], v[118:119]
  v_pk_mul_f32 v[58:59], v[58:59], v[132:133]
  v_pk_mul_f32 v[60:61], v[60:61], v[134:135]
  v_exp_f32 v48, v48
  v_exp_f32 v49, v49
  v_exp_f32 v50, v50
  v_exp_f32 v51, v51
  v_exp_f32 v58, v58
  v_exp_f32 v59, v59
  v_exp_f32 v60, v60
  v_exp_f32 v61, v61
  v_pk_add_f32 v[48:49], v[48:49], 1.0 op_sel_hi:[1,0]
  v_pk_add_f32 v[50:51], v[50:51], 1.0 op_sel_hi:[1,0]
  v_rcp_f32 v48, v48
  v_rcp_f32 v49, v49
  v_rcp_f32 v50, v50
  v_rcp_f32 v51, v51
  v_pk_add_f32 v[58:59], v[58:59], 1.0 op_sel_hi:[1,0]
  v_pk_add_f32 v[60:61], v[60:61], 1.0 op_sel_hi:[1,0]
  v_rcp_f32 v58, v58
  v_rcp_f32 v59, v59
  v_rcp_f32 v60, v60
  v_rcp_f32 v61, v61
  v_pk_mul_f32 v[116:117], v[116:117], v[48:49]
  v_pk_mul_f32 v[118:119], v[118:119], v[50:51]
  v_pk_mul_f32 v[132:133], v[132:133], v[58:59]
  v_pk_mul_f32 v[134:135], v[134:135], v[60:61]
  v_cvt_pk_bf16_f32 v24, v116, v117
  v_cvt_pk_bf16_f32 v25, v118, v119
  v_cvt_pk_bf16_f32 v26, v132, v133
  v_cvt_pk_bf16_f32 v27, v134, v135
  v_pk_mul_f32 v[48:49], v[148:149], v[148:149]
  v_pk_mul_f32 v[50:51], v[150:151], v[150:151]
  v_pk_mul_f32 v[58:59], v[164:165], v[164:165]
  v_pk_mul_f32 v[60:61], v[166:167], v[166:167]
  v_pk_fma_f32 v[48:49], v[48:49], s[46:47], v[56:57]
  v_pk_fma_f32 v[50:51], v[50:51], s[46:47], v[56:57]
  v_pk_fma_f32 v[58:59], v[58:59], s[46:47], v[56:57]
  v_pk_fma_f32 v[60:61], v[60:61], s[46:47], v[56:57]
  v_pk_mul_f32 v[48:49], v[48:49], v[148:149]
  v_pk_mul_f32 v[50:51], v[50:51], v[150:151]
  v_pk_mul_f32 v[58:59], v[58:59], v[164:165]
  v_pk_mul_f32 v[60:61], v[60:61], v[166:167]
  v_exp_f32 v48, v48
  v_exp_f32 v49, v49
  v_exp_f32 v50, v50
  v_exp_f32 v51, v51
  v_exp_f32 v58, v58
  v_exp_f32 v59, v59
  v_exp_f32 v60, v60
  v_exp_f32 v61, v61
  v_pk_add_f32 v[48:49], v[48:49], 1.0 op_sel_hi:[1,0]
  v_pk_add_f32 v[50:51], v[50:51], 1.0 op_sel_hi:[1,0]
  v_rcp_f32 v48, v48
  v_rcp_f32 v49, v49
  v_rcp_f32 v50, v50
  v_rcp_f32 v51, v51
  v_pk_add_f32 v[58:59], v[58:59], 1.0 op_sel_hi:[1,0]
  v_pk_add_f32 v[60:61], v[60:61], 1.0 op_sel_hi:[1,0]
  v_rcp_f32 v58, v58
  v_rcp_f32 v59, v59
  v_rcp_f32 v60, v60
  v_rcp_f32 v61, v61
  v_pk_mul_f32 v[148:149], v[148:149], v[48:49]
  v_pk_mul_f32 v[150:151], v[150:151], v[50:51]
  v_pk_mul_f32 v[164:165], v[164:165], v[58:59]
  v_pk_mul_f32 v[166:167], v[166:167], v[60:61]
  v_cvt_pk_bf16_f32 v28, v148, v149
  v_cvt_pk_bf16_f32 v29, v150, v151
  v_cvt_pk_bf16_f32 v30, v164, v165
  v_cvt_pk_bf16_f32 v31, v166, v167
  v_pk_mul_f32 v[48:49], v[120:121], v[120:121]
  v_pk_mul_f32 v[50:51], v[122:123], v[122:123]
  v_pk_mul_f32 v[58:59], v[136:137], v[136:137]
  v_pk_mul_f32 v[60:61], v[138:139], v[138:139]
  v_pk_fma_f32 v[48:49], v[48:49], s[46:47], v[56:57]
  v_pk_fma_f32 v[50:51], v[50:51], s[46:47], v[56:57]
  v_pk_fma_f32 v[58:59], v[58:59], s[46:47], v[56:57]
  v_pk_fma_f32 v[60:61], v[60:61], s[46:47], v[56:57]
  v_pk_mul_f32 v[48:49], v[48:49], v[120:121]
  v_pk_mul_f32 v[50:51], v[50:51], v[122:123]
  v_pk_mul_f32 v[58:59], v[58:59], v[136:137]
  v_pk_mul_f32 v[60:61], v[60:61], v[138:139]
  v_exp_f32 v48, v48
  v_exp_f32 v49, v49
  v_exp_f32 v50, v50
  v_exp_f32 v51, v51
  v_exp_f32 v58, v58
  v_exp_f32 v59, v59
  v_exp_f32 v60, v60
  v_exp_f32 v61, v61
  v_pk_add_f32 v[48:49], v[48:49], 1.0 op_sel_hi:[1,0]
  v_pk_add_f32 v[50:51], v[50:51], 1.0 op_sel_hi:[1,0]
  v_rcp_f32 v48, v48
  v_rcp_f32 v49, v49
  v_rcp_f32 v50, v50
  v_rcp_f32 v51, v51
  v_pk_add_f32 v[58:59], v[58:59], 1.0 op_sel_hi:[1,0]
  v_pk_add_f32 v[60:61], v[60:61], 1.0 op_sel_hi:[1,0]
  v_rcp_f32 v58, v58
  v_rcp_f32 v59, v59
  v_rcp_f32 v60, v60
  v_rcp_f32 v61, v61
  v_pk_mul_f32 v[120:121], v[120:121], v[48:49]
  v_pk_mul_f32 v[122:123], v[122:123], v[50:51]
  v_pk_mul_f32 v[136:137], v[136:137], v[58:59]
  v_pk_mul_f32 v[138:139], v[138:139], v[60:61]
  v_cvt_pk_bf16_f32 v32, v120, v121
  v_cvt_pk_bf16_f32 v33, v122, v123
  v_cvt_pk_bf16_f32 v34, v136, v137
  v_cvt_pk_bf16_f32 v35, v138, v139
  v_pk_mul_f32 v[48:49], v[152:153], v[152:153]
  v_pk_mul_f32 v[50:51], v[154:155], v[154:155]
  v_pk_mul_f32 v[58:59], v[168:169], v[168:169]
  v_pk_mul_f32 v[60:61], v[170:171], v[170:171]
  v_pk_fma_f32 v[48:49], v[48:49], s[46:47], v[56:57]
  v_pk_fma_f32 v[50:51], v[50:51], s[46:47], v[56:57]
  v_pk_fma_f32 v[58:59], v[58:59], s[46:47], v[56:57]
  v_pk_fma_f32 v[60:61], v[60:61], s[46:47], v[56:57]
  v_pk_mul_f32 v[48:49], v[48:49], v[152:153]
  v_pk_mul_f32 v[50:51], v[50:51], v[154:155]
  v_pk_mul_f32 v[58:59], v[58:59], v[168:169]
  v_pk_mul_f32 v[60:61], v[60:61], v[170:171]
  v_exp_f32 v48, v48
  v_exp_f32 v49, v49
  v_exp_f32 v50, v50
  v_exp_f32 v51, v51
  v_exp_f32 v58, v58
  v_exp_f32 v59, v59
  v_exp_f32 v60, v60
  v_exp_f32 v61, v61
  v_pk_add_f32 v[48:49], v[48:49], 1.0 op_sel_hi:[1,0]
  v_pk_add_f32 v[50:51], v[50:51], 1.0 op_sel_hi:[1,0]
  v_rcp_f32 v48, v48
  v_rcp_f32 v49, v49
  v_rcp_f32 v50, v50
  v_rcp_f32 v51, v51
  v_pk_add_f32 v[58:59], v[58:59], 1.0 op_sel_hi:[1,0]
  v_pk_add_f32 v[60:61], v[60:61], 1.0 op_sel_hi:[1,0]
  v_rcp_f32 v58, v58
  v_rcp_f32 v59, v59
  v_rcp_f32 v60, v60
  v_rcp_f32 v61, v61
  v_pk_mul_f32 v[152:153], v[152:153], v[48:49]
  v_pk_mul_f32 v[154:155], v[154:155], v[50:51]
  v_pk_mul_f32 v[168:169], v[168:169], v[58:59]
  v_pk_mul_f32 v[170:171], v[170:171], v[60:61]
  v_cvt_pk_bf16_f32 v36, v152, v153
  v_cvt_pk_bf16_f32 v37, v154, v155
  v_cvt_pk_bf16_f32 v38, v168, v169
  v_cvt_pk_bf16_f32 v39, v170, v171
  v_pk_mul_f32 v[48:49], v[124:125], v[124:125]
  v_pk_mul_f32 v[50:51], v[126:127], v[126:127]
  v_pk_mul_f32 v[58:59], v[140:141], v[140:141]
  v_pk_mul_f32 v[60:61], v[142:143], v[142:143]
  v_pk_fma_f32 v[48:49], v[48:49], s[46:47], v[56:57]
  v_pk_fma_f32 v[50:51], v[50:51], s[46:47], v[56:57]
  v_pk_fma_f32 v[58:59], v[58:59], s[46:47], v[56:57]
  v_pk_fma_f32 v[60:61], v[60:61], s[46:47], v[56:57]
  v_pk_mul_f32 v[48:49], v[48:49], v[124:125]
  v_pk_mul_f32 v[50:51], v[50:51], v[126:127]
  v_pk_mul_f32 v[58:59], v[58:59], v[140:141]
  v_pk_mul_f32 v[60:61], v[60:61], v[142:143]
  v_exp_f32 v48, v48
  v_exp_f32 v49, v49
  v_exp_f32 v50, v50
  v_exp_f32 v51, v51
  v_exp_f32 v58, v58
  v_exp_f32 v59, v59
  v_exp_f32 v60, v60
  v_exp_f32 v61, v61
  v_pk_add_f32 v[48:49], v[48:49], 1.0 op_sel_hi:[1,0]
  v_pk_add_f32 v[50:51], v[50:51], 1.0 op_sel_hi:[1,0]
  v_rcp_f32 v48, v48
  v_rcp_f32 v49, v49
  v_rcp_f32 v50, v50
  v_rcp_f32 v51, v51
  v_pk_add_f32 v[58:59], v[58:59], 1.0 op_sel_hi:[1,0]
  v_pk_add_f32 v[60:61], v[60:61], 1.0 op_sel_hi:[1,0]
  v_rcp_f32 v58, v58
  v_rcp_f32 v59, v59
  v_rcp_f32 v60, v60
  v_rcp_f32 v61, v61
  v_pk_mul_f32 v[124:125], v[124:125], v[48:49]
  v_pk_mul_f32 v[126:127], v[126:127], v[50:51]
  v_pk_mul_f32 v[140:141], v[140:141], v[58:59]
  v_pk_mul_f32 v[142:143], v[142:143], v[60:61]
  v_cvt_pk_bf16_f32 v40, v124, v125
  v_cvt_pk_bf16_f32 v41, v126, v127
  v_cvt_pk_bf16_f32 v42, v140, v141
  v_cvt_pk_bf16_f32 v43, v142, v143
  v_pk_mul_f32 v[48:49], v[156:157], v[156:157]
  v_pk_mul_f32 v[50:51], v[158:159], v[158:159]
  v_pk_mul_f32 v[58:59], v[172:173], v[172:173]
  v_pk_mul_f32 v[60:61], v[174:175], v[174:175]
  v_pk_fma_f32 v[48:49], v[48:49], s[46:47], v[56:57]
  v_pk_fma_f32 v[50:51], v[50:51], s[46:47], v[56:57]
  v_pk_fma_f32 v[58:59], v[58:59], s[46:47], v[56:57]
  v_pk_fma_f32 v[60:61], v[60:61], s[46:47], v[56:57]
  v_pk_mul_f32 v[48:49], v[48:49], v[156:157]
  v_pk_mul_f32 v[50:51], v[50:51], v[158:159]
  v_pk_mul_f32 v[58:59], v[58:59], v[172:173]
  v_pk_mul_f32 v[60:61], v[60:61], v[174:175]
  v_exp_f32 v48, v48
  v_exp_f32 v49, v49
  v_exp_f32 v50, v50
  v_exp_f32 v51, v51
  v_exp_f32 v58, v58
  v_exp_f32 v59, v59
  v_exp_f32 v60, v60
  v_exp_f32 v61, v61
  v_pk_add_f32 v[48:49], v[48:49], 1.0 op_sel_hi:[1,0]
  v_pk_add_f32 v[50:51], v[50:51], 1.0 op_sel_hi:[1,0]
  v_rcp_f32 v48, v48
  v_rcp_f32 v49, v49
  v_rcp_f32 v50, v50
  v_rcp_f32 v51, v51
  v_pk_add_f32 v[58:59], v[58:59], 1.0 op_sel_hi:[1,0]
  v_pk_add_f32 v[60:61], v[60:61], 1.0 op_sel_hi:[1,0]
  v_rcp_f32 v58, v58
  v_rcp_f32 v59, v59
  v_rcp_f32 v60, v60
  v_rcp_f32 v61, v61
  v_pk_mul_f32 v[156:157], v[156:157], v[48:49]
  v_pk_mul_f32 v[158:159], v[158:159], v[50:51]
  v_pk_mul_f32 v[172:173], v[172:173], v[58:59]
  v_pk_mul_f32 v[174:175], v[174:175], v[60:61]
  v_cvt_pk_bf16_f32 v44, v156, v157
  v_cvt_pk_bf16_f32 v45, v158, v159
  v_cvt_pk_bf16_f32 v46, v172, v173
  v_cvt_pk_bf16_f32 v47, v174, v175
  v_and_b32 v2, 31, v0
  v_min_u32 v2, 27, v2
  v_lshlrev_b32 v2, 9, v2
  s_mov_b32 s42, 0x20000
  s_add_u32 s48, s23, 4096
  s_add_u32 s49, s23, 8192
  s_add_u32 s50, s23, 12288
  s_branch g1fetch_58
g1poll_56:
  buffer_load_dword v56, v2, s[36:39], s23 offen offset:504 sc1
  s_waitcnt vmcnt(0)
  v_cmp_eq_u32 vcc, -1, v56
  s_sub_u32 s42, s42, 1
  s_cbranch_scc1 g1fetch_58
  s_cmp_eq_u64 vcc, 0
  s_cbranch_scc1 g1fetch_58
  s_sleep 1
  s_branch g1poll_56
g1fetch_58:
  buffer_load_dwordx2 v[56:57], v1, s[36:39], s23 offen offset:0 sc1
  buffer_load_dwordx2 v[58:59], v1, s[36:39], s23 offen offset:512 sc1
  buffer_load_dwordx2 v[60:61], v1, s[36:39], s23 offen offset:1024 sc1
  buffer_load_dwordx2 v[62:63], v1, s[36:39], s23 offen offset:1536 sc1
  buffer_load_dwordx2 v[64:65], v1, s[36:39], s23 offen offset:2048 sc1
  buffer_load_dwordx2 v[66:67], v1, s[36:39], s23 offen offset:2560 sc1
  buffer_load_dwordx2 v[68:69], v1, s[36:39], s23 offen offset:3072 sc1
  buffer_load_dwordx2 v[70:71], v1, s[36:39], s23 offen offset:3584 sc1
  buffer_load_dwordx2 v[72:73], v1, s[36:39], s48 offen offset:0 sc1
  buffer_load_dwordx2 v[74:75], v1, s[36:39], s48 offen offset:512 sc1
  buffer_load_dwordx2 v[76:77], v1, s[36:39], s48 offen offset:1024 sc1
  buffer_load_dwordx2 v[78:79], v1, s[36:39], s48 offen offset:1536 sc1
  buffer_load_dwordx2 v[80:81], v1, s[36:39], s48 offen offset:2048 sc1
  buffer_load_dwordx2 v[82:83], v1, s[36:39], s48 offen offset:2560 sc1
  buffer_load_dwordx2 v[84:85], v1, s[36:39], s48 offen offset:3072 sc1
  buffer_load_dwordx2 v[86:87], v1, s[36:39], s48 offen offset:3584 sc1
  buffer_load_dwordx2 v[88:89], v1, s[36:39], s49 offen offset:0 sc1
  buffer_load_dwordx2 v[90:91], v1, s[36:39], s49 offen offset:512 sc1
  buffer_load_dwordx2 v[92:93], v1, s[36:39], s49 offen offset:1024 sc1
  buffer_load_dwordx2 v[94:95], v1, s[36:39], s49 offen offset:1536 sc1
  buffer_load_dwordx2 v[96:97], v1, s[36:39], s49 offen offset:2048 sc1
  buffer_load_dwordx2 v[98:99], v1, s[36:39], s49 offen offset:2560 sc1
  buffer_load_dwordx2 v[100:101], v1, s[36:39], s49 offen offset:3072 sc1
  buffer_load_dwordx2 v[102:103], v1, s[36:39], s49 offen offset:3584 sc1
  buffer_load_dwordx2 v[104:105], v1, s[36:39], s50 offen offset:0 sc1
  buffer_load_dwordx2 v[106:107], v1, s[36:39], s50 offen offset:512 sc1
  buffer_load_dwordx2 v[108:109], v1, s[36:39], s50 offen offset:1024 sc1
  buffer_load_dwordx2 v[110:111], v1, s[36:39], s50 offen offset:1536 sc1
  s_waitcnt vmcnt(0)
  v_max_u32 v3, v56, v57
  v_max3_u32 v3, v3, v58, v59
  v_max3_u32 v3, v3, v60, v61
  v_max3_u32 v3, v3, v62, v63
  v_max3_u32 v3, v3, v64, v65
  v_max3_u32 v3, v3, v66, v67
  v_max3_u32 v3, v3, v68, v69
  v_max3_u32 v3, v3, v70, v71
  v_max3_u32 v3, v3, v72, v73
  v_max3_u32 v3, v3, v74, v75
  v_max3_u32 v3, v3, v76, v77
  v_max3_u32 v3, v3, v78, v79
  v_max3_u32 v3, v3, v80, v81
  v_max3_u32 v3, v3, v82, v83
  v_max3_u32 v3, v3, v84, v85
  v_max3_u32 v3, v3, v86, v87
  v_max3_u32 v3, v3, v88, v89
  v_max3_u32 v3, v3, v90, v91
  v_max3_u32 v3, v3, v92, v93
  v_max3_u32 v3, v3, v94, v95
  v_max3_u32 v3, v3, v96, v97
  v_max3_u32 v3, v3, v98, v99
  v_max3_u32 v3, v3, v100, v101
  v_max3_u32 v3, v3, v102, v103
  v_max3_u32 v3, v3, v104, v105
  v_max3_u32 v3, v3, v106, v107
  v_max3_u32 v3, v3, v108, v109
  v_max3_u32 v3, v3, v110, v111
  v_cmp_eq_u32 vcc, -1, v3
  s_sub_u32 s42, s42, 1
  s_cbranch_scc1 g1polld_57
  s_cmp_eq_u64 vcc, 0
  s_cbranch_scc0 g1poll_56
g1polld_57:
  v_pk_add_f32 v[56:57], v[56:57], v[110:111]
  v_pk_add_f32 v[58:59], v[58:59], v[108:109]
  v_pk_add_f32 v[60:61], v[60:61], v[106:107]
  v_pk_add_f32 v[62:63], v[62:63], v[104:105]
  v_pk_add_f32 v[64:65], v[64:65], v[102:103]
  v_pk_add_f32 v[66:67], v[66:67], v[100:101]
  v_pk_add_f32 v[68:69], v[68:69], v[98:99]
  v_pk_add_f32 v[70:71], v[70:71], v[96:97]
  v_pk_add_f32 v[72:73], v[72:73], v[94:95]
  v_pk_add_f32 v[74:75], v[74:75], v[92:93]
  v_pk_add_f32 v[76:77], v[76:77], v[90:91]
  v_pk_add_f32 v[78:79], v[78:79], v[88:89]
  v_pk_add_f32 v[80:81], v[80:81], v[86:87]
  v_pk_add_f32 v[82:83], v[82:83], v[84:85]
  v_pk_add_f32 v[56:57], v[56:57], v[82:83]
  v_pk_add_f32 v[58:59], v[58:59], v[80:81]
  v_pk_add_f32 v[60:61], v[60:61], v[78:79]
  v_pk_add_f32 v[62:63], v[62:63], v[76:77]
  v_pk_add_f32 v[64:65], v[64:65], v[74:75]
  v_pk_add_f32 v[66:67], v[66:67], v[72:73]
  v_pk_add_f32 v[68:69], v[68:69], v[70:71]
  v_pk_add_f32 v[56:57], v[56:57], v[68:69]
  v_pk_add_f32 v[58:59], v[58:59], v[66:67]
  v_pk_add_f32 v[60:61], v[60:61], v[64:65]
  v_pk_add_f32 v[56:57], v[56:57], v[62:63]
  v_pk_add_f32 v[58:59], v[58:59], v[60:61]
  v_pk_add_f32 v[56:57], v[56:57], v[58:59]
  s_mov_b32 s44, 974276901
  s_mov_b32 s45, 925353388
  v_mul_f32 v56, s44, v56
  v_mul_f32 v57, s44, v57
  v_fma_f32 v57, -v56, v56, v57
  v_max_f32 v57, 0, v57
  v_cvt_pk_bf16_f32 v56, v56, v56
  v_lshlrev_b32 v56, 16, v56
  v_cvt_pk_bf16_f32 v57, v57, v57
  v_lshlrev_b32 v57, 16, v57
  v_add_f32 v57, s45, v57
  v_cvt_pk_bf16_f32 v57, v57, v57
  v_lshlrev_b32 v57, 16, v57
  v_sqrt_f32 v57, v57
  s_nop 0
  v_cvt_pk_bf16_f32 v57, v57, v57
  v_lshlrev_b32 v57, 16, v57
  v_rcp_f32 v57, v57
  s_nop 0
  v_sub_f32 v56, 0, v56
  v_mov_b32 v64, v56
  v_mov_b32 v66, v56
  s_nop 1
  v_permlane16_swap_b32 v64, v66
  v_mov_b32 v68, v64
  v_mov_b32 v70, v66
  s_nop 1
  v_permlane32_swap_b32 v64, v68
  v_permlane32_swap_b32 v66, v70
  v_mov_b32 v65, v64
  v_mov_b32 v67, v66
  v_mov_b32 v69, v68
  v_mov_b32 v71, v70
  v_mov_b32 v72, v57
  v_mov_b32 v74, v57
  s_nop 1
  v_permlane16_swap_b32 v72, v74
  v_mov_b32 v76, v72
  v_mov_b32 v78, v74
  s_nop 1
  v_permlane32_swap_b32 v72, v76
  v_permlane32_swap_b32 v74, v78
  v_mov_b32 v73, v72
  v_mov_b32 v75, v74
  v_mov_b32 v77, v76
  v_mov_b32 v79, v78
  s_add_u32 s12, s30, 50331648
  s_addc_u32 s13, s31, 0
  s_mov_b32 s14, 7340032
  s_mov_b32 s15, 0x20000
  s_mul_i32 s23, s28, 64
  s_add_u32 s23, s23, s18
  v_and_b32 v4, 15, v0
  v_add_u32 v4, s23, v4
  s_mov_b32 s24, 3584
  v_mul_lo_u32 v4, v4, s24
  s_mul_i32 s23, s27, 64
  s_add_u32 s23, s23, s17
  s_lshl_b32 s23, s23, 1
  v_lshrrev_b32 v5, 4, v0
  v_lshlrev_b32 v5, 3, v5
  v_add3_u32 v4, v4, v5, s23
  v_lshrrev_b32 v6, 4, v0
  v_lshlrev_b32 v7, 3, v6
  v_sub_u32 v4, v4, v7
  v_and_b32 v7, 1, v6
  v_lshlrev_b32 v7, 5, v7
  v_lshrrev_b32 v6, 1, v6
  v_lshlrev_b32 v6, 4, v6
  v_add3_u32 v4, v4, v6, v7
  v_pk_add_f32 v[176:177], v[176:177], v[64:65]
  v_pk_mul_f32 v[176:177], v[176:177], v[72:73]
  v_pk_add_f32 v[178:179], v[178:179], v[64:65]
  v_pk_mul_f32 v[178:179], v[178:179], v[72:73]
  v_cvt_pk_bf16_f32 v80, v176, v177
  v_cvt_pk_bf16_f32 v81, v178, v179
  v_pk_add_f32 v[192:193], v[192:193], v[64:65]
  v_pk_mul_f32 v[192:193], v[192:193], v[72:73]
  v_pk_add_f32 v[194:195], v[194:195], v[64:65]
  v_pk_mul_f32 v[194:195], v[194:195], v[72:73]
  v_cvt_pk_bf16_f32 v82, v192, v193
  v_cvt_pk_bf16_f32 v83, v194, v195
  v_pk_add_f32 v[208:209], v[208:209], v[64:65]
  v_pk_mul_f32 v[208:209], v[208:209], v[72:73]
  v_pk_add_f32 v[210:211], v[210:211], v[64:65]
  v_pk_mul_f32 v[210:211], v[210:211], v[72:73]
  v_cvt_pk_bf16_f32 v84, v208, v209
  v_cvt_pk_bf16_f32 v85, v210, v211
  v_pk_add_f32 v[224:225], v[224:225], v[64:65]
  v_pk_mul_f32 v[224:225], v[224:225], v[72:73]
  v_pk_add_f32 v[226:227], v[226:227], v[64:65]
  v_pk_mul_f32 v[226:227], v[226:227], v[72:73]
  v_cvt_pk_bf16_f32 v86, v224, v225
  v_cvt_pk_bf16_f32 v87, v226, v227
  s_mov_b32 s24, 0
  s_nop 1
  v_permlane16_swap_b32 v80, v82
  v_permlane16_swap_b32 v81, v83
  buffer_store_dwordx4 v[80:83], v4, s[12:15], s24 offen offset:0 sc1
  v_permlane16_swap_b32 v84, v86
  v_permlane16_swap_b32 v85, v87
  buffer_store_dwordx4 v[84:87], v4, s[12:15], s24 offen offset:64 sc1
  v_pk_add_f32 v[180:181], v[180:181], v[66:67]
  v_pk_mul_f32 v[180:181], v[180:181], v[74:75]
  v_pk_add_f32 v[182:183], v[182:183], v[66:67]
  v_pk_mul_f32 v[182:183], v[182:183], v[74:75]
  v_cvt_pk_bf16_f32 v88, v180, v181
  v_cvt_pk_bf16_f32 v89, v182, v183
  v_pk_add_f32 v[196:197], v[196:197], v[66:67]
  v_pk_mul_f32 v[196:197], v[196:197], v[74:75]
  v_pk_add_f32 v[198:199], v[198:199], v[66:67]
  v_pk_mul_f32 v[198:199], v[198:199], v[74:75]
  v_cvt_pk_bf16_f32 v90, v196, v197
  v_cvt_pk_bf16_f32 v91, v198, v199
  v_pk_add_f32 v[212:213], v[212:213], v[66:67]
  v_pk_mul_f32 v[212:213], v[212:213], v[74:75]
  v_pk_add_f32 v[214:215], v[214:215], v[66:67]
  v_pk_mul_f32 v[214:215], v[214:215], v[74:75]
  v_cvt_pk_bf16_f32 v92, v212, v213
  v_cvt_pk_bf16_f32 v93, v214, v215
  v_pk_add_f32 v[228:229], v[228:229], v[66:67]
  v_pk_mul_f32 v[228:229], v[228:229], v[74:75]
  v_pk_add_f32 v[230:231], v[230:231], v[66:67]
  v_pk_mul_f32 v[230:231], v[230:231], v[74:75]
  v_cvt_pk_bf16_f32 v94, v228, v229
  v_cvt_pk_bf16_f32 v95, v230, v231
  s_mov_b32 s24, 57344
  s_nop 1
  v_permlane16_swap_b32 v88, v90
  v_permlane16_swap_b32 v89, v91
  buffer_store_dwordx4 v[88:91], v4, s[12:15], s24 offen offset:0 sc1
  v_permlane16_swap_b32 v92, v94
  v_permlane16_swap_b32 v93, v95
  buffer_store_dwordx4 v[92:95], v4, s[12:15], s24 offen offset:64 sc1
  v_pk_add_f32 v[184:185], v[184:185], v[68:69]
  v_pk_mul_f32 v[184:185], v[184:185], v[76:77]
  v_pk_add_f32 v[186:187], v[186:187], v[68:69]
  v_pk_mul_f32 v[186:187], v[186:187], v[76:77]
  v_cvt_pk_bf16_f32 v96, v184, v185
  v_cvt_pk_bf16_f32 v97, v186, v187
  v_pk_add_f32 v[200:201], v[200:201], v[68:69]
  v_pk_mul_f32 v[200:201], v[200:201], v[76:77]
  v_pk_add_f32 v[202:203], v[202:203], v[68:69]
  v_pk_mul_f32 v[202:203], v[202:203], v[76:77]
  v_cvt_pk_bf16_f32 v98, v200, v201
  v_cvt_pk_bf16_f32 v99, v202, v203
  v_pk_add_f32 v[216:217], v[216:217], v[68:69]
  v_pk_mul_f32 v[216:217], v[216:217], v[76:77]
  v_pk_add_f32 v[218:219], v[218:219], v[68:69]
  v_pk_mul_f32 v[218:219], v[218:219], v[76:77]
  v_cvt_pk_bf16_f32 v100, v216, v217
  v_cvt_pk_bf16_f32 v101, v218, v219
  v_pk_add_f32 v[232:233], v[232:233], v[68:69]
  v_pk_mul_f32 v[232:233], v[232:233], v[76:77]
  v_pk_add_f32 v[234:235], v[234:235], v[68:69]
  v_pk_mul_f32 v[234:235], v[234:235], v[76:77]
  v_cvt_pk_bf16_f32 v102, v232, v233
  v_cvt_pk_bf16_f32 v103, v234, v235
  s_mov_b32 s24, 114688
  s_nop 1
  v_permlane16_swap_b32 v96, v98
  v_permlane16_swap_b32 v97, v99
  buffer_store_dwordx4 v[96:99], v4, s[12:15], s24 offen offset:0 sc1
  v_permlane16_swap_b32 v100, v102
  v_permlane16_swap_b32 v101, v103
  buffer_store_dwordx4 v[100:103], v4, s[12:15], s24 offen offset:64 sc1
  v_pk_add_f32 v[188:189], v[188:189], v[70:71]
  v_pk_mul_f32 v[188:189], v[188:189], v[78:79]
  v_pk_add_f32 v[190:191], v[190:191], v[70:71]
  v_pk_mul_f32 v[190:191], v[190:191], v[78:79]
  v_cvt_pk_bf16_f32 v104, v188, v189
  v_cvt_pk_bf16_f32 v105, v190, v191
  v_pk_add_f32 v[204:205], v[204:205], v[70:71]
  v_pk_mul_f32 v[204:205], v[204:205], v[78:79]
  v_pk_add_f32 v[206:207], v[206:207], v[70:71]
  v_pk_mul_f32 v[206:207], v[206:207], v[78:79]
  v_cvt_pk_bf16_f32 v106, v204, v205
  v_cvt_pk_bf16_f32 v107, v206, v207
  v_pk_add_f32 v[220:221], v[220:221], v[70:71]
  v_pk_mul_f32 v[220:221], v[220:221], v[78:79]
  v_pk_add_f32 v[222:223], v[222:223], v[70:71]
  v_pk_mul_f32 v[222:223], v[222:223], v[78:79]
  v_cvt_pk_bf16_f32 v108, v220, v221
  v_cvt_pk_bf16_f32 v109, v222, v223
  v_pk_add_f32 v[236:237], v[236:237], v[70:71]
  v_pk_mul_f32 v[236:237], v[236:237], v[78:79]
  v_pk_add_f32 v[238:239], v[238:239], v[70:71]
  v_pk_mul_f32 v[238:239], v[238:239], v[78:79]
  v_cvt_pk_bf16_f32 v110, v236, v237
  v_cvt_pk_bf16_f32 v111, v238, v239
  s_mov_b32 s24, 172032
  s_nop 1
  v_permlane16_swap_b32 v104, v106
  v_permlane16_swap_b32 v105, v107
  buffer_store_dwordx4 v[104:107], v4, s[12:15], s24 offen offset:0 sc1
  v_permlane16_swap_b32 v108, v110
  v_permlane16_swap_b32 v109, v111
  buffer_store_dwordx4 v[108:111], v4, s[12:15], s24 offen offset:64 sc1
  s_branch g1_end_50
g1_skip_48:
  s_and_b32 s24, s2, 7
  s_lshl_b32 s24, s24, 2
  s_sub_u32 s23, s29, 28
  s_add_u32 s23, s23, s24
  v_lshl_add_u32 v4, s16, 6, v0
  v_lshlrev_b32 v4, 4, v4
  s_mov_b32 s56, s90
  s_mov_b32 s57, s91
  s_mov_b32 s58, 8388608
  s_mov_b32 s59, 0x20000
  s_mul_i32 s54, s23, 262144
  s_mov_b32 s55, 32
pfl_59:
  buffer_load_dwordx4 v[8:11], v4, s[56:59], s54 offen
  s_add_u32 s54, s54, 8192
  s_waitcnt vmcnt(6)
  s_sub_u32 s55, s55, 1
  s_cmp_lg_u32 s55, 0
  s_cbranch_scc1 pfl_59
  s_mov_b32 s56, s94
  s_mov_b32 s57, s95
  s_mov_b32 s58, 3670016
  s_mov_b32 s59, 0x20000
  s_add_u32 s48, s30, 41943040
  s_addc_u32 s49, s31, 0
  s_mov_b32 s50, 3670016
  s_mov_b32 s51, 0x20000
  v_lshl_add_u32 v5, s16, 6, v0
  v_bfe_u32 v6, v5, 3, 4
  s_mov_b32 s54, 229376
  v_mul_lo_u32 v6, v6, s54
  v_lshrrev_b32 v7, 7, v5
  v_lshl_add_u32 v6, v7, 7, v6
  v_and_b32 v7, 7, v5
  v_lshl_add_u32 v6, v7, 4, v6
  s_mul_i32 s54, s23, 114688
  s_mul_i32 s55, s23, 7168
  buffer_load_dwordx4 v[12:15], v4, s[56:59], s54 offen
  s_add_u32 s54, s54, 8192
  buffer_load_dwordx4 v[16:19], v4, s[56:59], s54 offen
  s_add_u32 s54, s54, 8192
  buffer_load_dwordx4 v[20:23], v4, s[56:59], s54 offen
  s_add_u32 s54, s54, 8192
  buffer_load_dwordx4 v[24:27], v4, s[56:59], s54 offen
  s_add_u32 s54, s54, 8192
  buffer_load_dwordx4 v[28:31], v4, s[56:59], s54 offen
  s_add_u32 s54, s54, 8192
  buffer_load_dwordx4 v[32:35], v4, s[56:59], s54 offen
  s_add_u32 s54, s54, 8192
  buffer_load_dwordx4 v[36:39], v4, s[56:59], s54 offen
  s_add_u32 s54, s54, 8192
  s_waitcnt vmcnt(6)
  buffer_store_dwordx4 v[12:15], v6, s[48:51], s55 offen sc1
  s_add_u32 s55, s55, 512
  s_waitcnt vmcnt(6)
  buffer_store_dwordx4 v[16:19], v6, s[48:51], s55 offen sc1
  s_add_u32 s55, s55, 512
  s_waitcnt vmcnt(6)
  buffer_store_dwordx4 v[20:23], v6, s[48:51], s55 offen sc1
  s_add_u32 s55, s55, 512
  s_waitcnt vmcnt(6)
  buffer_store_dwordx4 v[24:27], v6, s[48:51], s55 offen sc1
  s_add_u32 s55, s55, 512
  s_waitcnt vmcnt(6)
  buffer_store_dwordx4 v[28:31], v6, s[48:51], s55 offen sc1
  s_add_u32 s55, s55, 512
  s_waitcnt vmcnt(6)
  buffer_store_dwordx4 v[32:35], v6, s[48:51], s55 offen sc1
  s_add_u32 s55, s55, 512
  s_waitcnt vmcnt(6)
  buffer_store_dwordx4 v[36:39], v6, s[48:51], s55 offen sc1
  s_add_u32 s55, s55, 512
  s_waitcnt vmcnt(0)
  buffer_load_dwordx4 v[12:15], v4, s[56:59], s54 offen
  s_add_u32 s54, s54, 8192
  buffer_load_dwordx4 v[16:19], v4, s[56:59], s54 offen
  s_add_u32 s54, s54, 8192
  buffer_load_dwordx4 v[20:23], v4, s[56:59], s54 offen
  s_add_u32 s54, s54, 8192
  buffer_load_dwordx4 v[24:27], v4, s[56:59], s54 offen
  s_add_u32 s54, s54, 8192
  buffer_load_dwordx4 v[28:31], v4, s[56:59], s54 offen
  s_add_u32 s54, s54, 8192
  buffer_load_dwordx4 v[32:35], v4, s[56:59], s54 offen
  s_add_u32 s54, s54, 8192
  buffer_load_dwordx4 v[36:39], v4, s[56:59], s54 offen
  s_add_u32 s54, s54, 8192
  s_waitcnt vmcnt(6)
  buffer_store_dwordx4 v[12:15], v6, s[48:51], s55 offen sc1
  s_add_u32 s55, s55, 512
  s_waitcnt vmcnt(6)
  buffer_store_dwordx4 v[16:19], v6, s[48:51], s55 offen sc1
  s_add_u32 s55, s55, 512
  s_waitcnt vmcnt(6)
  buffer_store_dwordx4 v[20:23], v6, s[48:51], s55 offen sc1
  s_add_u32 s55, s55, 512
  s_waitcnt vmcnt(6)
  buffer_store_dwordx4 v[24:27], v6, s[48:51], s55 offen sc1
  s_add_u32 s55, s55, 512
  s_waitcnt vmcnt(6)
  buffer_store_dwordx4 v[28:31], v6, s[48:51], s55 offen sc1
  s_add_u32 s55, s55, 512
  s_waitcnt vmcnt(6)
  buffer_store_dwordx4 v[32:35], v6, s[48:51], s55 offen sc1
  s_add_u32 s55, s55, 512
  s_waitcnt vmcnt(6)
  buffer_store_dwordx4 v[36:39], v6, s[48:51], s55 offen sc1
  s_add_u32 s55, s55, 512
  s_waitcnt vmcnt(0)
g1_end_50:
  s_waitcnt vmcnt(0) lgkmcnt(0)
  s_barrier
  s_cmp_lg_u32 s16, 0
  s_cbranch_scc1 arr_60
  s_add_u32 s64, s30, 71434240
  s_addc_u32 s65, s31, 0
  s_mov_b32 s66, 32768
  s_mov_b32 s67, 0x20000
  s_and_b32 s3, s2, 15
  s_lshl_b32 s3, s3, 8
  v_lshlrev_b32 v250, 12, v0
  v_add_u32 v250, s3, v250
  v_mov_b32 v251, 1
  s_mov_b64 exec, 0xff
  buffer_atomic_add v251, v250, s[64:67], 0 offen sc1
  s_mov_b64 exec, -1
arr_60:
  s_and_b32 s3, s2, 7
  s_lshr_b32 s29, s2, 3
  s_cmp_ge_u32 s29, 28
  s_cbranch_scc1 g2_skip_61
  s_and_b32 s18, s3, 3
  s_lshl_b32 s18, s18, 2
  s_and_b32 s23, s29, 3
  s_add_u32 s18, s18, s23
  s_mov_b32 s40, s18
  s_lshl_b32 s18, s18, 7
  s_lshr_b32 s17, s3, 2
  s_mul_i32 s17, s17, 7
  s_lshr_b32 s23, s29, 2
  s_add_u32 s17, s17, s23
  s_mov_b32 s41, s17
  s_lshl_b32 s17, s17, 7
  s_add_u32 s4, s30, 50331648
  s_addc_u32 s5, s31, 0
  s_mov_b32 s6, 7340032
  s_mov_b32 s7, 0x20000
  s_mov_b32 s8, s90
  s_mov_b32 s9, s91
  s_mov_b32 s10, 8388608
  s_mov_b32 s11, 0x20000
  s_cmp_lt_u32 s16, 4
  s_cbranch_scc1 g2_cons_62
  s_sub_u32 s25, s16, 4
  s_lshl_b32 s23, s25, 6
  s_add_u32 s23, s23, 0
  v_add_u32 v9, s23, v0
  v_lshrrev_b32 v10, 4, v9
  v_and_b32 v9, 15, v9
  v_and_b32 v11, 3, v10
  v_lshlrev_b32 v11, 1, v11
  v_xor_b32 v9, v9, v11
  v_and_b32 v11, 8, v10
  v_xor_b32 v9, v9, v11
  v_lshlrev_b32 v9, 4, v9
  s_mov_b32 s24, 3584
  v_mul_lo_u32 v10, v10, s24
  v_add_u32 v1, v9, v10
  s_lshl_b32 s23, s25, 6
  s_add_u32 s23, s23, 256
  v_add_u32 v9, s23, v0
  v_lshrrev_b32 v10, 4, v9
  v_and_b32 v9, 15, v9
  v_and_b32 v11, 3, v10
  v_lshlrev_b32 v11, 1, v11
  v_xor_b32 v9, v9, v11
  v_and_b32 v11, 8, v10
  v_xor_b32 v9, v9, v11
  v_lshlrev_b32 v9, 4, v9
  s_mov_b32 s24, 3584
  v_mul_lo_u32 v10, v10, s24
  v_add_u32 v2, v9, v10
  s_lshl_b32 s23, s25, 6
  s_add_u32 s23, s23, 512
  v_add_u32 v9, s23, v0
  v_lshrrev_b32 v10, 4, v9
  v_and_b32 v9, 15, v9
  v_and_b32 v11, 3, v10
  v_lshlrev_b32 v11, 1, v11
  v_xor_b32 v9, v9, v11
  v_and_b32 v11, 8, v10
  v_xor_b32 v9, v9, v11
  v_lshlrev_b32 v9, 4, v9
  s_mov_b32 s24, 3584
  v_mul_lo_u32 v10, v10, s24
  v_add_u32 v3, v9, v10
  s_lshl_b32 s23, s25, 6
  s_add_u32 s23, s23, 768
  v_add_u32 v9, s23, v0
  v_lshrrev_b32 v10, 4, v9
  v_and_b32 v9, 15, v9
  v_and_b32 v11, 3, v10
  v_lshlrev_b32 v11, 1, v11
  v_xor_b32 v9, v9, v11
  v_and_b32 v11, 8, v10
  v_xor_b32 v9, v9, v11
  v_lshlrev_b32 v9, 4, v9
  s_mov_b32 s24, 3584
  v_mul_lo_u32 v10, v10, s24
  v_add_u32 v4, v9, v10
  s_and_b32 s23, s25, 1
  s_lshl_b32 s23, s23, 2
  v_lshrrev_b32 v9, 4, v0
  v_xor_b32 v9, s23, v9
  v_and_b32 v10, 7, v0
  v_xor_b32 v9, v9, v10
  v_lshlrev_b32 v9, 4, v9
  s_lshl_b32 s23, s25, 3
  s_add_u32 s23, s23, 0
  v_lshrrev_b32 v10, 3, v0
  v_add_u32 v10, s23, v10
  s_mov_b32 s24, 4096
  v_mul_lo_u32 v10, v10, s24
  v_add_u32 v5, v9, v10
  s_and_b32 s23, s25, 1
  s_lshl_b32 s23, s23, 2
  v_lshrrev_b32 v9, 4, v0
  v_xor_b32 v9, s23, v9
  v_and_b32 v10, 7, v0
  v_xor_b32 v9, v9, v10
  v_lshlrev_b32 v9, 4, v9
  s_lshl_b32 s23, s25, 3
  s_add_u32 s23, s23, 32
  v_lshrrev_b32 v10, 3, v0
  v_add_u32 v10, s23, v10
  s_mov_b32 s24, 4096
  v_mul_lo_u32 v10, v10, s24
  v_add_u32 v6, v9, v10
  s_and_b32 s23, s25, 1
  s_lshl_b32 s23, s23, 2
  v_lshrrev_b32 v9, 4, v0
  v_xor_b32 v9, s23, v9
  v_and_b32 v10, 7, v0
  v_xor_b32 v9, v9, v10
  v_lshlrev_b32 v9, 4, v9
  s_lshl_b32 s23, s25, 3
  s_add_u32 s23, s23, 64
  v_lshrrev_b32 v10, 3, v0
  v_add_u32 v10, s23, v10
  s_mov_b32 s24, 4096
  v_mul_lo_u32 v10, v10, s24
  v_add_u32 v7, v9, v10
  s_and_b32 s23, s25, 1
  s_lshl_b32 s23, s23, 2
  v_lshrrev_b32 v9, 4, v0
  v_xor_b32 v9, s23, v9
  v_and_b32 v10, 7, v0
  v_xor_b32 v9, v9, v10
  v_lshlrev_b32 v9, 4, v9
  s_lshl_b32 s23, s25, 3
  s_add_u32 s23, s23, 96
  v_lshrrev_b32 v10, 3, v0
  v_add_u32 v10, s23, v10
  s_mov_b32 s24, 4096
  v_mul_lo_u32 v10, v10, s24
  v_add_u32 v8, v9, v10
  s_lshl_b32 s19, s17, 1
  s_mul_i32 s20, s18, 4096
  s_lshl_b32 s21, s25, 10
  s_add_u32 s26, s21, 131072
  s_add_u32 m0, s21, 16384
  s_nop 0
  buffer_load_dwordx4 v5, s[8:11], s20 offen  lds
  s_add_u32 m0, s21, 20480
  s_nop 0
  buffer_load_dwordx4 v6, s[8:11], s20 offen  lds
  s_add_u32 m0, s21, 24576
  s_nop 0
  buffer_load_dwordx4 v7, s[8:11], s20 offen  lds
  s_add_u32 m0, s21, 28672
  s_nop 0
  buffer_load_dwordx4 v8, s[8:11], s20 offen  lds
  s_add_u32 s20, s20, 128
  s_add_u32 s21, s21, 32768
  s_cmp_ge_u32 s21, s26
  s_cselect_b32 s23, 131072, 0
  s_sub_u32 s21, s21, s23
  s_add_u32 m0, s21, 16384
  s_nop 0
  buffer_load_dwordx4 v5, s[8:11], s20 offen  lds
  s_add_u32 m0, s21, 20480
  s_nop 0
  buffer_load_dwordx4 v6, s[8:11], s20 offen  lds
  s_add_u32 m0, s21, 24576
  s_nop 0
  buffer_load_dwordx4 v7, s[8:11], s20 offen  lds
  s_add_u32 m0, s21, 28672
  s_nop 0
  buffer_load_dwordx4 v8, s[8:11], s20 offen  lds
  s_add_u32 s20, s20, 128
  s_add_u32 s21, s21, 32768
  s_cmp_ge_u32 s21, s26
  s_cselect_b32 s23, 131072, 0
  s_sub_u32 s21, s21, s23
  s_add_u32 m0, s21, 16384
  s_nop 0
  buffer_load_dwordx4 v5, s[8:11], s20 offen  lds
  s_add_u32 m0, s21, 20480
  s_nop 0
  buffer_load_dwordx4 v6, s[8:11], s20 offen  lds
  s_add_u32 m0, s21, 24576
  s_nop 0
  buffer_load_dwordx4 v7, s[8:11], s20 offen  lds
  s_add_u32 m0, s21, 28672
  s_nop 0
  buffer_load_dwordx4 v8, s[8:11], s20 offen  lds
  s_add_u32 s20, s20, 128
  s_add_u32 s21, s21, 32768
  s_cmp_ge_u32 s21, s26
  s_cselect_b32 s23, 131072, 0
  s_sub_u32 s21, s21, s23
  s_add_u32 m0, s21, 16384
  s_nop 0
  buffer_load_dwordx4 v5, s[8:11], s20 offen  lds
  s_add_u32 m0, s21, 20480
  s_nop 0
  buffer_load_dwordx4 v6, s[8:11], s20 offen  lds
  s_add_u32 m0, s21, 24576
  s_nop 0
  buffer_load_dwordx4 v7, s[8:11], s20 offen  lds
  s_add_u32 m0, s21, 28672
  s_nop 0
  buffer_load_dwordx4 v8, s[8:11], s20 offen  lds
  s_add_u32 s20, s20, 128
  s_add_u32 s21, s21, 32768
  s_cmp_ge_u32 s21, s26
  s_cselect_b32 s23, 131072, 0
  s_sub_u32 s21, s21, s23
  s_barrier
  s_add_u32 m0, s21, 0
  s_nop 0
  buffer_load_dwordx4 v1, s[4:7], s19 offen sc1 lds
  s_add_u32 m0, s21, 4096
  s_nop 0
  buffer_load_dwordx4 v2, s[4:7], s19 offen sc1 lds
  s_add_u32 m0, s21, 8192
  s_nop 0
  buffer_load_dwordx4 v3, s[4:7], s19 offen sc1 lds
  s_add_u32 m0, s21, 12288
  s_nop 0
  buffer_load_dwordx4 v4, s[4:7], s19 offen sc1 lds
  s_add_u32 s19, s19, 229376
  s_add_u32 s21, s21, 32768
  s_cmp_ge_u32 s21, s26
  s_cselect_b32 s23, 131072, 0
  s_sub_u32 s21, s21, s23
  s_add_u32 m0, s21, 0
  s_nop 0
  buffer_load_dwordx4 v1, s[4:7], s19 offen sc1 lds
  s_add_u32 m0, s21, 4096
  s_nop 0
  buffer_load_dwordx4 v2, s[4:7], s19 offen sc1 lds
  s_add_u32 m0, s21, 8192
  s_nop 0
  buffer_load_dwordx4 v3, s[4:7], s19 offen sc1 lds
  s_add_u32 m0, s21, 12288
  s_nop 0
  buffer_load_dwordx4 v4, s[4:7], s19 offen sc1 lds
  s_add_u32 s19, s19, 229376
  s_add_u32 s21, s21, 32768
  s_cmp_ge_u32 s21, s26
  s_cselect_b32 s23, 131072, 0
  s_sub_u32 s21, s21, s23
  s_add_u32 m0, s21, 0
  s_nop 0
  buffer_load_dwordx4 v1, s[4:7], s19 offen sc1 lds
  s_add_u32 m0, s21, 4096
  s_nop 0
  buffer_load_dwordx4 v2, s[4:7], s19 offen sc1 lds
  s_add_u32 m0, s21, 8192
  s_nop 0
  buffer_load_dwordx4 v3, s[4:7], s19 offen sc1 lds
  s_add_u32 m0, s21, 12288
  s_nop 0
  buffer_load_dwordx4 v4, s[4:7], s19 offen sc1 lds
  s_add_u32 s19, s19, 229376
  s_add_u32 s21, s21, 32768
  s_cmp_ge_u32 s21, s26
  s_cselect_b32 s23, 131072, 0
  s_sub_u32 s21, s21, s23
  s_add_u32 m0, s21, 0
  s_nop 0
  buffer_load_dwordx4 v1, s[4:7], s19 offen sc1 lds
  s_add_u32 m0, s21, 4096
  s_nop 0
  buffer_load_dwordx4 v2, s[4:7], s19 offen sc1 lds
  s_add_u32 m0, s21, 8192
  s_nop 0
  buffer_load_dwordx4 v3, s[4:7], s19 offen sc1 lds
  s_add_u32 m0, s21, 12288
  s_nop 0
  buffer_load_dwordx4 v4, s[4:7], s19 offen sc1 lds
  s_add_u32 s19, s19, 229376
  s_add_u32 s21, s21, 32768
  s_cmp_ge_u32 s21, s26
  s_cselect_b32 s23, 131072, 0
  s_sub_u32 s21, s21, s23
  s_waitcnt vmcnt(12)
  s_barrier
  s_waitcnt vmcnt(8)
  s_barrier
  s_add_u32 m0, s21, 0
  s_nop 0
  buffer_load_dwordx4 v1, s[4:7], s19 offen sc1 lds
  s_add_u32 m0, s21, 4096
  s_nop 0
  buffer_load_dwordx4 v2, s[4:7], s19 offen sc1 lds
  s_add_u32 m0, s21, 8192
  s_nop 0
  buffer_load_dwordx4 v3, s[4:7], s19 offen sc1 lds
  s_add_u32 m0, s21, 12288
  s_nop 0
  buffer_load_dwordx4 v4, s[4:7], s19 offen sc1 lds
  s_add_u32 m0, s21, 16384
  s_nop 0
  buffer_load_dwordx4 v5, s[8:11], s20 offen  lds
  s_add_u32 m0, s21, 20480
  s_nop 0
  buffer_load_dwordx4 v6, s[8:11], s20 offen  lds
  s_add_u32 m0, s21, 24576
  s_nop 0
  buffer_load_dwordx4 v7, s[8:11], s20 offen  lds
  s_add_u32 m0, s21, 28672
  s_nop 0
  buffer_load_dwordx4 v8, s[8:11], s20 offen  lds
  s_add_u32 s19, s19, 229376
  s_add_u32 s20, s20, 128
  s_add_u32 s21, s21, 32768
  s_cmp_ge_u32 s21, s26
  s_cselect_b32 s23, 131072, 0
  s_sub_u32 s21, s21, s23
  s_waitcnt vmcnt(12)
  s_barrier
  s_add_u32 m0, s21, 0
  s_nop 0
  buffer_load_dwordx4 v1, s[4:7], s19 offen sc1 lds
  s_add_u32 m0, s21, 4096
  s_nop 0
  buffer_load_dwordx4 v2, s[4:7], s19 offen sc1 lds
  s_add_u32 m0, s21, 8192
  s_nop 0
  buffer_load_dwordx4 v3, s[4:7], s19 offen sc1 lds
  s_add_u32 m0, s21, 12288
  s_nop 0
  buffer_load_dwordx4 v4, s[4:7], s19 offen sc1 lds
  s_add_u32 m0, s21, 16384
  s_nop 0
  buffer_load_dwordx4 v5, s[8:11], s20 offen  lds
  s_add_u32 m0, s21, 20480
  s_nop 0
  buffer_load_dwordx4 v6, s[8:11], s20 offen  lds
  s_add_u32 m0, s21, 24576
  s_nop 0
  buffer_load_dwordx4 v7, s[8:11], s20 offen  lds
  s_add_u32 m0, s21, 28672
  s_nop 0
  buffer_load_dwordx4 v8, s[8:11], s20 offen  lds
  s_add_u32 s19, s19, 229376
  s_add_u32 s20, s20, 128
  s_add_u32 s21, s21, 32768
  s_cmp_ge_u32 s21, s26
  s_cselect_b32 s23, 131072, 0
  s_sub_u32 s21, s21, s23
  s_waitcnt vmcnt(16)
  s_barrier
  s_add_u32 m0, s21, 0
  s_nop 0
  buffer_load_dwordx4 v1, s[4:7], s19 offen sc1 lds
  s_add_u32 m0, s21, 4096
  s_nop 0
  buffer_load_dwordx4 v2, s[4:7], s19 offen sc1 lds
  s_add_u32 m0, s21, 8192
  s_nop 0
  buffer_load_dwordx4 v3, s[4:7], s19 offen sc1 lds
  s_add_u32 m0, s21, 12288
  s_nop 0
  buffer_load_dwordx4 v4, s[4:7], s19 offen sc1 lds
  s_add_u32 m0, s21, 16384
  s_nop 0
  buffer_load_dwordx4 v5, s[8:11], s20 offen  lds
  s_add_u32 m0, s21, 20480
  s_nop 0
  buffer_load_dwordx4 v6, s[8:11], s20 offen  lds
  s_add_u32 m0, s21, 24576
  s_nop 0
  buffer_load_dwordx4 v7, s[8:11], s20 offen  lds
  s_add_u32 m0, s21, 28672
  s_nop 0
  buffer_load_dwordx4 v8, s[8:11], s20 offen  lds
  s_add_u32 s19, s19, 229376
  s_add_u32 s20, s20, 128
  s_add_u32 s21, s21, 32768
  s_cmp_ge_u32 s21, s26
  s_cselect_b32 s23, 131072, 0
  s_sub_u32 s21, s21, s23
  s_mov_b32 s22, 25
g2_pl_64:
  s_waitcnt vmcnt(16)
  s_barrier
  s_add_u32 m0, s21, 0
  s_nop 0
  buffer_load_dwordx4 v1, s[4:7], s19 offen sc1 lds
  s_add_u32 m0, s21, 4096
  s_nop 0
  buffer_load_dwordx4 v2, s[4:7], s19 offen sc1 lds
  s_add_u32 m0, s21, 8192
  s_nop 0
  buffer_load_dwordx4 v3, s[4:7], s19 offen sc1 lds
  s_add_u32 m0, s21, 12288
  s_nop 0
  buffer_load_dwordx4 v4, s[4:7], s19 offen sc1 lds
  s_add_u32 m0, s21, 16384
  s_nop 0
  buffer_load_dwordx4 v5, s[8:11], s20 offen  lds
  s_add_u32 m0, s21, 20480
  s_nop 0
  buffer_load_dwordx4 v6, s[8:11], s20 offen  lds
  s_add_u32 m0, s21, 24576
  s_nop 0
  buffer_load_dwordx4 v7, s[8:11], s20 offen  lds
  s_add_u32 m0, s21, 28672
  s_nop 0
  buffer_load_dwordx4 v8, s[8:11], s20 offen  lds
  s_add_u32 s19, s19, 229376
  s_add_u32 s20, s20, 128
  s_add_u32 s21, s21, 32768
  s_cmp_ge_u32 s21, s26
  s_cselect_b32 s23, 131072, 0
  s_sub_u32 s21, s21, s23
  s_sub_u32 s22, s22, 1
  s_cmp_lg_u32 s22, 0
  s_cbranch_scc1 g2_pl_64
  s_waitcnt vmcnt(16)
  s_barrier
  s_waitcnt vmcnt(8)
  s_barrier
  s_waitcnt vmcnt(0)
  s_barrier
  s_branch g2_end_63
g2_cons_62:
  s_and_b32 s27, s16, 1
  s_lshr_b32 s28, s16, 1
  v_lshrrev_b32 v60, 4, v0
  v_bfe_u32 v61, v0, 2, 2
  v_and_b32 v62, 1, v60
  v_lshlrev_b32 v62, 2, v62
  v_or_b32 v62, v62, v61
  v_lshl_add_u32 v60, v60, 3, v61
  s_mov_b32 s24, 256
  v_mul_lo_u32 v60, v60, s24
  s_mul_i32 s23, s27, 4
  s_add_u32 s23, s23, 0
  v_xor_b32 v62, s23, v62
  v_lshlrev_b32 v62, 5, v62
  v_add_u32 v60, v60, v62
  v_and_b32 v61, 3, v0
  v_lshlrev_b32 v61, 3, v61
  v_add_u32 v60, v60, v61
  v_add_u32 v48, 0, v60
  v_lshrrev_b32 v60, 4, v0
  v_bfe_u32 v61, v0, 2, 2
  v_and_b32 v62, 1, v60
  v_lshlrev_b32 v62, 2, v62
  v_or_b32 v62, v62, v61
  v_lshl_add_u32 v60, v60, 3, v61
  s_mov_b32 s24, 256
  v_mul_lo_u32 v60, v60, s24
  s_mul_i32 s23, s27, 4
  s_add_u32 s23, s23, 1
  v_xor_b32 v62, s23, v62
  v_lshlrev_b32 v62, 5, v62
  v_add_u32 v60, v60, v62
  v_and_b32 v61, 3, v0
  v_lshlrev_b32 v61, 3, v61
  v_add_u32 v60, v60, v61
  v_add_u32 v49, 0, v60
  v_lshrrev_b32 v60, 4, v0
  v_bfe_u32 v61, v0, 2, 2
  v_and_b32 v62, 1, v60
  v_lshlrev_b32 v62, 2, v62
  v_or_b32 v62, v62, v61
  v_lshl_add_u32 v60, v60, 3, v61
  s_mov_b32 s24, 256
  v_mul_lo_u32 v60, v60, s24
  s_mul_i32 s23, s27, 4
  s_add_u32 s23, s23, 2
  v_xor_b32 v62, s23, v62
  v_lshlrev_b32 v62, 5, v62
  v_add_u32 v60, v60, v62
  v_and_b32 v61, 3, v0
  v_lshlrev_b32 v61, 3, v61
  v_add_u32 v60, v60, v61
  v_add_u32 v50, 0, v60
  v_lshrrev_b32 v60, 4, v0
  v_bfe_u32 v61, v0, 2, 2
  v_and_b32 v62, 1, v60
  v_lshlrev_b32 v62, 2, v62
  v_or_b32 v62, v62, v61
  v_lshl_add_u32 v60, v60, 3, v61
  s_mov_b32 s24, 256
  v_mul_lo_u32 v60, v60, s24
  s_mul_i32 s23, s27, 4
  s_add_u32 s23, s23, 3
  v_xor_b32 v62, s23, v62
  v_lshlrev_b32 v62, 5, v62
  v_add_u32 v60, v60, v62
  v_and_b32 v61, 3, v0
  v_lshlrev_b32 v61, 3, v61
  v_add_u32 v60, v60, v61
  v_add_u32 v51, 0, v60
  v_and_b32 v60, 15, v0
  v_lshrrev_b32 v61, 1, v60
  v_lshrrev_b32 v62, 4, v0
  v_xor_b32 v61, v61, v62
  v_lshlrev_b32 v61, 4, v61
  v_lshlrev_b32 v60, 7, v60
  v_add_u32 v60, v60, v61
  s_mul_i32 s23, s28, 8192
  s_add_u32 s23, s23, 16384
  v_add_u32 v52, s23, v60
  v_and_b32 v60, 15, v0
  v_lshrrev_b32 v61, 1, v60
  v_lshrrev_b32 v62, 4, v0
  v_xor_b32 v61, v61, v62
  v_xor_b32 v61, 4, v61
  v_lshlrev_b32 v61, 4, v61
  v_lshlrev_b32 v60, 7, v60
  v_add_u32 v60, v60, v61
  s_mul_i32 s23, s28, 8192
  s_add_u32 s23, s23, 16384
  v_add_u32 v53, s23, v60
  s_mov_b32 s21, 0
  v_add_u32 v54, s21, v48
  v_add_u32 v55, s21, v49
  v_add_u32 v56, s21, v50
  v_add_u32 v57, s21, v51
  v_add_u32 v58, s21, v52
  v_add_u32 v59, s21, v53
  v_lshlrev_b32 v240, 16, v240
  v_lshlrev_b32 v241, 16, v241
  v_lshlrev_b32 v242, 16, v242
  v_lshlrev_b32 v243, 16, v243
  v_mov_b32 v124, v240
  v_mov_b32 v125, v240
  v_mov_b32 v126, v240
  v_mov_b32 v127, v240
  v_mov_b32 v128, v241
  v_mov_b32 v129, v241
  v_mov_b32 v130, v241
  v_mov_b32 v131, v241
  v_mov_b32 v132, v242
  v_mov_b32 v133, v242
  v_mov_b32 v134, v242
  v_mov_b32 v135, v242
  v_mov_b32 v136, v243
  v_mov_b32 v137, v243
  v_mov_b32 v138, v243
  v_mov_b32 v139, v243
  v_mov_b32 v140, v240
  v_mov_b32 v141, v240
  v_mov_b32 v142, v240
  v_mov_b32 v143, v240
  v_mov_b32 v144, v241
  v_mov_b32 v145, v241
  v_mov_b32 v146, v241
  v_mov_b32 v147, v241
  v_mov_b32 v148, v242
  v_mov_b32 v149, v242
  v_mov_b32 v150, v242
  v_mov_b32 v151, v242
  v_mov_b32 v152, v243
  v_mov_b32 v153, v243
  v_mov_b32 v154, v243
  v_mov_b32 v155, v243
  v_mov_b32 v156, v240
  v_mov_b32 v157, v240
  v_mov_b32 v158, v240
  v_mov_b32 v159, v240
  v_mov_b32 v160, v241
  v_mov_b32 v161, v241
  v_mov_b32 v162, v241
  v_mov_b32 v163, v241
  v_mov_b32 v164, v242
  v_mov_b32 v165, v242
  v_mov_b32 v166, v242
  v_mov_b32 v167, v242
  v_mov_b32 v168, v243
  v_mov_b32 v169, v243
  v_mov_b32 v170, v243
  v_mov_b32 v171, v243
  v_mov_b32 v172, v240
  v_mov_b32 v173, v240
  v_mov_b32 v174, v240
  v_mov_b32 v175, v240
  v_mov_b32 v176, v241
  v_mov_b32 v177, v241
  v_mov_b32 v178, v241
  v_mov_b32 v179, v241
  v_mov_b32 v180, v242
  v_mov_b32 v181, v242
  v_mov_b32 v182, v242
  v_mov_b32 v183, v242
  v_mov_b32 v184, v243
  v_mov_b32 v185, v243
  v_mov_b32 v186, v243
  v_mov_b32 v187, v243
  s_cmp_lg_u32 s16, 0
  s_cbranch_scc1 pw_65
  s_add_u32 s64, s30, 71434240
  s_addc_u32 s65, s31, 0
  s_mov_b32 s66, 32768
  s_mov_b32 s67, 0x20000
  s_bfe_u32 s3, s2, 0x30004
  s_lshl_b32 s3, s3, 12
  v_and_b32 v250, 15, v0
  v_lshlrev_b32 v250, 8, v250
  v_add_u32 v250, s3, v250
  s_mov_b32 s3, 0x20000
  buffer_load_dword v251, v250, s[64:67], 0 offen sc1
pl_66:
  s_waitcnt vmcnt(0)
  v_cmp_gt_u32 vcc, 16, v251
  s_sub_u32 s3, s3, 1
  s_cbranch_scc1 pd_67
  s_cmp_eq_u64 vcc, 0
  s_cbranch_scc1 pd_67
  s_sleep 1
  buffer_load_dword v251, v250, s[64:67], 0 offen sc1
  s_branch pl_66
pd_67:
pw_65:
  s_barrier
  s_barrier
  ds_read_b128 v[76:79], v58 offset:0
  ds_read_b64_tr_b16 v[60:61], v54 offset:0
  ds_read_b64_tr_b16 v[62:63], v54 offset:1024
  ds_read_b128 v[80:83], v58 offset:2048
  ds_read_b128 v[84:87], v58 offset:4096
  ds_read_b128 v[88:91], v58 offset:6144
  ds_read_b64_tr_b16 v[64:65], v55 offset:0
  ds_read_b64_tr_b16 v[66:67], v55 offset:1024
  ds_read_b64_tr_b16 v[68:69], v56 offset:0
  ds_read_b64_tr_b16 v[70:71], v56 offset:1024
  ds_read_b64_tr_b16 v[72:73], v57 offset:0
  ds_read_b64_tr_b16 v[74:75], v57 offset:1024
  s_waitcnt lgkmcnt(0)
  s_mov_b32 s22, 31
g2_cl_68:
  v_mfma_f32_16x16x32_bf16 v[124:127], v[60:63], v[76:79], v[124:127]
  ds_read_b128 v[108:111], v59 offset:0
  ds_read_b64_tr_b16 v[92:93], v54 offset:8192
  v_mfma_f32_16x16x32_bf16 v[128:131], v[60:63], v[80:83], v[128:131]
  ds_read_b64_tr_b16 v[94:95], v54 offset:9216
  ds_read_b128 v[112:115], v59 offset:2048
  v_mfma_f32_16x16x32_bf16 v[132:135], v[60:63], v[84:87], v[132:135]
  ds_read_b128 v[116:119], v59 offset:4096
  ds_read_b128 v[120:123], v59 offset:6144
  v_mfma_f32_16x16x32_bf16 v[136:139], v[60:63], v[88:91], v[136:139]
  ds_read_b64_tr_b16 v[96:97], v55 offset:8192
  ds_read_b64_tr_b16 v[98:99], v55 offset:9216
  v_mfma_f32_16x16x32_bf16 v[140:143], v[64:67], v[76:79], v[140:143]
  ds_read_b64_tr_b16 v[100:101], v56 offset:8192
  ds_read_b64_tr_b16 v[102:103], v56 offset:9216
  v_mfma_f32_16x16x32_bf16 v[144:147], v[64:67], v[80:83], v[144:147]
  ds_read_b64_tr_b16 v[104:105], v57 offset:8192
  ds_read_b64_tr_b16 v[106:107], v57 offset:9216
  v_mfma_f32_16x16x32_bf16 v[148:151], v[64:67], v[84:87], v[148:151]
  s_add_u32 s21, s21, 32768
  s_cmp_ge_u32 s21, 131072
  v_mfma_f32_16x16x32_bf16 v[152:155], v[64:67], v[88:91], v[152:155]
  s_cselect_b32 s23, 131072, 0
  s_sub_u32 s21, s21, s23
  v_mfma_f32_16x16x32_bf16 v[156:159], v[68:71], v[76:79], v[156:159]
  v_add_u32 v54, s21, v48
  v_add_u32 v55, s21, v49
  v_mfma_f32_16x16x32_bf16 v[160:163], v[68:71], v[80:83], v[160:163]
  v_add_u32 v56, s21, v50
  v_add_u32 v57, s21, v51
  v_mfma_f32_16x16x32_bf16 v[164:167], v[68:71], v[84:87], v[164:167]
  v_add_u32 v58, s21, v52
  v_add_u32 v59, s21, v53
  v_mfma_f32_16x16x32_bf16 v[168:171], v[68:71], v[88:91], v[168:171]
  v_mfma_f32_16x16x32_bf16 v[172:175], v[72:75], v[76:79], v[172:175]
  v_mfma_f32_16x16x32_bf16 v[176:179], v[72:75], v[80:83], v[176:179]
  v_mfma_f32_16x16x32_bf16 v[180:183], v[72:75], v[84:87], v[180:183]
  v_mfma_f32_16x16x32_bf16 v[184:187], v[72:75], v[88:91], v[184:187]
  s_waitcnt lgkmcnt(0)
  s_barrier
  v_mfma_f32_16x16x32_bf16 v[124:127], v[92:95], v[108:111], v[124:127]
  ds_read_b128 v[76:79], v58 offset:0
  ds_read_b64_tr_b16 v[60:61], v54 offset:0
  v_mfma_f32_16x16x32_bf16 v[128:131], v[92:95], v[112:115], v[128:131]
  ds_read_b64_tr_b16 v[62:63], v54 offset:1024
  ds_read_b128 v[80:83], v58 offset:2048
  v_mfma_f32_16x16x32_bf16 v[132:135], v[92:95], v[116:119], v[132:135]
  ds_read_b128 v[84:87], v58 offset:4096
  ds_read_b128 v[88:91], v58 offset:6144
  v_mfma_f32_16x16x32_bf16 v[136:139], v[92:95], v[120:123], v[136:139]
  ds_read_b64_tr_b16 v[64:65], v55 offset:0
  ds_read_b64_tr_b16 v[66:67], v55 offset:1024
  v_mfma_f32_16x16x32_bf16 v[140:143], v[96:99], v[108:111], v[140:143]
  ds_read_b64_tr_b16 v[68:69], v56 offset:0
  ds_read_b64_tr_b16 v[70:71], v56 offset:1024
  v_mfma_f32_16x16x32_bf16 v[144:147], v[96:99], v[112:115], v[144:147]
  ds_read_b64_tr_b16 v[72:73], v57 offset:0
  ds_read_b64_tr_b16 v[74:75], v57 offset:1024
  v_mfma_f32_16x16x32_bf16 v[148:151], v[96:99], v[116:119], v[148:151]
  s_sub_u32 s22, s22, 1
  v_mfma_f32_16x16x32_bf16 v[152:155], v[96:99], v[120:123], v[152:155]
  v_mfma_f32_16x16x32_bf16 v[156:159], v[100:103], v[108:111], v[156:159]
  v_mfma_f32_16x16x32_bf16 v[160:163], v[100:103], v[112:115], v[160:163]
  v_mfma_f32_16x16x32_bf16 v[164:167], v[100:103], v[116:119], v[164:167]
  v_mfma_f32_16x16x32_bf16 v[168:171], v[100:103], v[120:123], v[168:171]
  v_mfma_f32_16x16x32_bf16 v[172:175], v[104:107], v[108:111], v[172:175]
  v_mfma_f32_16x16x32_bf16 v[176:179], v[104:107], v[112:115], v[176:179]
  v_mfma_f32_16x16x32_bf16 v[180:183], v[104:107], v[116:119], v[180:183]
  v_mfma_f32_16x16x32_bf16 v[184:187], v[104:107], v[120:123], v[184:187]
  s_waitcnt lgkmcnt(0)
  s_cmp_lg_u32 s22, 0
  s_cbranch_scc1 g2_cl_68
  v_mfma_f32_16x16x32_bf16 v[124:127], v[60:63], v[76:79], v[124:127]
  ds_read_b128 v[108:111], v59 offset:0
  ds_read_b64_tr_b16 v[92:93], v54 offset:8192
  v_mfma_f32_16x16x32_bf16 v[128:131], v[60:63], v[80:83], v[128:131]
  ds_read_b64_tr_b16 v[94:95], v54 offset:9216
  ds_read_b128 v[112:115], v59 offset:2048
  v_mfma_f32_16x16x32_bf16 v[132:135], v[60:63], v[84:87], v[132:135]
  ds_read_b128 v[116:119], v59 offset:4096
  ds_read_b128 v[120:123], v59 offset:6144
  v_mfma_f32_16x16x32_bf16 v[136:139], v[60:63], v[88:91], v[136:139]
  ds_read_b64_tr_b16 v[96:97], v55 offset:8192
  ds_read_b64_tr_b16 v[98:99], v55 offset:9216
  v_mfma_f32_16x16x32_bf16 v[140:143], v[64:67], v[76:79], v[140:143]
  ds_read_b64_tr_b16 v[100:101], v56 offset:8192
  ds_read_b64_tr_b16 v[102:103], v56 offset:9216
  v_mfma_f32_16x16x32_bf16 v[144:147], v[64:67], v[80:83], v[144:147]
  ds_read_b64_tr_b16 v[104:105], v57 offset:8192
  ds_read_b64_tr_b16 v[106:107], v57 offset:9216
  v_mfma_f32_16x16x32_bf16 v[148:151], v[64:67], v[84:87], v[148:151]
  v_mfma_f32_16x16x32_bf16 v[152:155], v[64:67], v[88:91], v[152:155]
  v_mfma_f32_16x16x32_bf16 v[156:159], v[68:71], v[76:79], v[156:159]
  v_mfma_f32_16x16x32_bf16 v[160:163], v[68:71], v[80:83], v[160:163]
  v_mfma_f32_16x16x32_bf16 v[164:167], v[68:71], v[84:87], v[164:167]
  v_mfma_f32_16x16x32_bf16 v[168:171], v[68:71], v[88:91], v[168:171]
  v_mfma_f32_16x16x32_bf16 v[172:175], v[72:75], v[76:79], v[172:175]
  v_mfma_f32_16x16x32_bf16 v[176:179], v[72:75], v[80:83], v[176:179]
  v_mfma_f32_16x16x32_bf16 v[180:183], v[72:75], v[84:87], v[180:183]
  v_mfma_f32_16x16x32_bf16 v[184:187], v[72:75], v[88:91], v[184:187]
  s_waitcnt lgkmcnt(0)
  v_mfma_f32_16x16x32_bf16 v[124:127], v[92:95], v[108:111], v[124:127]
  v_mfma_f32_16x16x32_bf16 v[128:131], v[92:95], v[112:115], v[128:131]
  v_mfma_f32_16x16x32_bf16 v[132:135], v[92:95], v[116:119], v[132:135]
  v_mfma_f32_16x16x32_bf16 v[136:139], v[92:95], v[120:123], v[136:139]
  v_mfma_f32_16x16x32_bf16 v[140:143], v[96:99], v[108:111], v[140:143]
  v_mfma_f32_16x16x32_bf16 v[144:147], v[96:99], v[112:115], v[144:147]
  v_mfma_f32_16x16x32_bf16 v[148:151], v[96:99], v[116:119], v[148:151]
  v_mfma_f32_16x16x32_bf16 v[152:155], v[96:99], v[120:123], v[152:155]
  v_mfma_f32_16x16x32_bf16 v[156:159], v[100:103], v[108:111], v[156:159]
  v_mfma_f32_16x16x32_bf16 v[160:163], v[100:103], v[112:115], v[160:163]
  v_mfma_f32_16x16x32_bf16 v[164:167], v[100:103], v[116:119], v[164:167]
  v_mfma_f32_16x16x32_bf16 v[168:171], v[100:103], v[120:123], v[168:171]
  v_mfma_f32_16x16x32_bf16 v[172:175], v[104:107], v[108:111], v[172:175]
  v_mfma_f32_16x16x32_bf16 v[176:179], v[104:107], v[112:115], v[176:179]
  v_mfma_f32_16x16x32_bf16 v[180:183], v[104:107], v[116:119], v[180:183]
  v_mfma_f32_16x16x32_bf16 v[184:187], v[104:107], v[120:123], v[184:187]
  s_add_u32 s12, s30, 58720256
  s_addc_u32 s13, s31, 0
  s_mov_b32 s14, 7340032
  s_mov_b32 s15, 0x20000
  s_mul_i32 s23, s28, 64
  s_add_u32 s23, s23, s18
  v_and_b32 v192, 15, v0
  v_add_u32 v192, s23, v192
  s_mov_b32 s24, 3584
  v_mul_lo_u32 v192, v192, s24
  s_mul_i32 s23, s27, 64
  s_add_u32 s23, s23, s17
  s_lshl_b32 s23, s23, 1
  v_lshrrev_b32 v193, 4, v0
  v_lshlrev_b32 v193, 3, v193
  v_add3_u32 v192, v192, v193, s23
  s_mov_b32 s26, 0xffff0000
  v_lshrrev_b32 v196, 4, v0
  v_lshlrev_b32 v197, 3, v196
  v_sub_u32 v192, v192, v197
  v_and_b32 v197, 1, v196
  v_lshlrev_b32 v197, 5, v197
  v_lshrrev_b32 v196, 1, v196
  v_lshlrev_b32 v196, 4, v196
  v_add3_u32 v192, v192, v196, v197
  v_lshlrev_b32 v196, 16, v16
  v_and_b32 v197, s26, v16
  v_lshlrev_b32 v198, 16, v17
  v_and_b32 v199, s26, v17
  v_pk_mul_f32 v[124:125], v[124:125], v[196:197]
  v_pk_mul_f32 v[126:127], v[126:127], v[198:199]
  v_cvt_pk_bf16_f32 v16, v124, v125
  v_cvt_pk_bf16_f32 v17, v126, v127
  v_lshlrev_b32 v200, 16, v18
  v_and_b32 v201, s26, v18
  v_lshlrev_b32 v202, 16, v19
  v_and_b32 v203, s26, v19
  v_pk_mul_f32 v[140:141], v[140:141], v[200:201]
  v_pk_mul_f32 v[142:143], v[142:143], v[202:203]
  v_cvt_pk_bf16_f32 v18, v140, v141
  v_cvt_pk_bf16_f32 v19, v142, v143
  v_lshlrev_b32 v196, 16, v20
  v_and_b32 v197, s26, v20
  v_lshlrev_b32 v198, 16, v21
  v_and_b32 v199, s26, v21
  v_pk_mul_f32 v[156:157], v[156:157], v[196:197]
  v_pk_mul_f32 v[158:159], v[158:159], v[198:199]
  v_cvt_pk_bf16_f32 v20, v156, v157
  v_cvt_pk_bf16_f32 v21, v158, v159
  v_lshlrev_b32 v200, 16, v22
  v_and_b32 v201, s26, v22
  v_lshlrev_b32 v202, 16, v23
  v_and_b32 v203, s26, v23
  v_pk_mul_f32 v[172:173], v[172:173], v[200:201]
  v_pk_mul_f32 v[174:175], v[174:175], v[202:203]
  v_cvt_pk_bf16_f32 v22, v172, v173
  v_cvt_pk_bf16_f32 v23, v174, v175
  s_mov_b32 s24, 0
  s_nop 1
  v_permlane16_swap_b32 v16, v18
  v_permlane16_swap_b32 v17, v19
  buffer_store_dwordx4 v[16:19], v192, s[12:15], s24 offen offset:0 sc1
  v_permlane16_swap_b32 v20, v22
  v_permlane16_swap_b32 v21, v23
  buffer_store_dwordx4 v[20:23], v192, s[12:15], s24 offen offset:64 sc1
  v_lshlrev_b32 v200, 16, v24
  v_and_b32 v201, s26, v24
  v_lshlrev_b32 v202, 16, v25
  v_and_b32 v203, s26, v25
  v_pk_mul_f32 v[128:129], v[128:129], v[200:201]
  v_pk_mul_f32 v[130:131], v[130:131], v[202:203]
  v_cvt_pk_bf16_f32 v24, v128, v129
  v_cvt_pk_bf16_f32 v25, v130, v131
  v_lshlrev_b32 v196, 16, v26
  v_and_b32 v197, s26, v26
  v_lshlrev_b32 v198, 16, v27
  v_and_b32 v199, s26, v27
  v_pk_mul_f32 v[144:145], v[144:145], v[196:197]
  v_pk_mul_f32 v[146:147], v[146:147], v[198:199]
  v_cvt_pk_bf16_f32 v26, v144, v145
  v_cvt_pk_bf16_f32 v27, v146, v147
  v_lshlrev_b32 v200, 16, v28
  v_and_b32 v201, s26, v28
  v_lshlrev_b32 v202, 16, v29
  v_and_b32 v203, s26, v29
  v_pk_mul_f32 v[160:161], v[160:161], v[200:201]
  v_pk_mul_f32 v[162:163], v[162:163], v[202:203]
  v_cvt_pk_bf16_f32 v28, v160, v161
  v_cvt_pk_bf16_f32 v29, v162, v163
  v_lshlrev_b32 v196, 16, v30
  v_and_b32 v197, s26, v30
  v_lshlrev_b32 v198, 16, v31
  v_and_b32 v199, s26, v31
  v_pk_mul_f32 v[176:177], v[176:177], v[196:197]
  v_pk_mul_f32 v[178:179], v[178:179], v[198:199]
  v_cvt_pk_bf16_f32 v30, v176, v177
  v_cvt_pk_bf16_f32 v31, v178, v179
  s_mov_b32 s24, 57344
  s_nop 1
  v_permlane16_swap_b32 v24, v26
  v_permlane16_swap_b32 v25, v27
  buffer_store_dwordx4 v[24:27], v192, s[12:15], s24 offen offset:0 sc1
  v_permlane16_swap_b32 v28, v30
  v_permlane16_swap_b32 v29, v31
  buffer_store_dwordx4 v[28:31], v192, s[12:15], s24 offen offset:64 sc1
  v_lshlrev_b32 v196, 16, v32
  v_and_b32 v197, s26, v32
  v_lshlrev_b32 v198, 16, v33
  v_and_b32 v199, s26, v33
  v_pk_mul_f32 v[132:133], v[132:133], v[196:197]
  v_pk_mul_f32 v[134:135], v[134:135], v[198:199]
  v_cvt_pk_bf16_f32 v32, v132, v133
  v_cvt_pk_bf16_f32 v33, v134, v135
  v_lshlrev_b32 v200, 16, v34
  v_and_b32 v201, s26, v34
  v_lshlrev_b32 v202, 16, v35
  v_and_b32 v203, s26, v35
  v_pk_mul_f32 v[148:149], v[148:149], v[200:201]
  v_pk_mul_f32 v[150:151], v[150:151], v[202:203]
  v_cvt_pk_bf16_f32 v34, v148, v149
  v_cvt_pk_bf16_f32 v35, v150, v151
  v_lshlrev_b32 v196, 16, v36
  v_and_b32 v197, s26, v36
  v_lshlrev_b32 v198, 16, v37
  v_and_b32 v199, s26, v37
  v_pk_mul_f32 v[164:165], v[164:165], v[196:197]
  v_pk_mul_f32 v[166:167], v[166:167], v[198:199]
  v_cvt_pk_bf16_f32 v36, v164, v165
  v_cvt_pk_bf16_f32 v37, v166, v167
  v_lshlrev_b32 v200, 16, v38
  v_and_b32 v201, s26, v38
  v_lshlrev_b32 v202, 16, v39
  v_and_b32 v203, s26, v39
  v_pk_mul_f32 v[180:181], v[180:181], v[200:201]
  v_pk_mul_f32 v[182:183], v[182:183], v[202:203]
  v_cvt_pk_bf16_f32 v38, v180, v181
  v_cvt_pk_bf16_f32 v39, v182, v183
  s_mov_b32 s24, 114688
  s_nop 1
  v_permlane16_swap_b32 v32, v34
  v_permlane16_swap_b32 v33, v35
  buffer_store_dwordx4 v[32:35], v192, s[12:15], s24 offen offset:0 sc1
  v_permlane16_swap_b32 v36, v38
  v_permlane16_swap_b32 v37, v39
  buffer_store_dwordx4 v[36:39], v192, s[12:15], s24 offen offset:64 sc1
  v_lshlrev_b32 v200, 16, v40
  v_and_b32 v201, s26, v40
  v_lshlrev_b32 v202, 16, v41
  v_and_b32 v203, s26, v41
  v_pk_mul_f32 v[136:137], v[136:137], v[200:201]
  v_pk_mul_f32 v[138:139], v[138:139], v[202:203]
  v_cvt_pk_bf16_f32 v40, v136, v137
  v_cvt_pk_bf16_f32 v41, v138, v139
  v_lshlrev_b32 v196, 16, v42
  v_and_b32 v197, s26, v42
  v_lshlrev_b32 v198, 16, v43
  v_and_b32 v199, s26, v43
  v_pk_mul_f32 v[152:153], v[152:153], v[196:197]
  v_pk_mul_f32 v[154:155], v[154:155], v[198:199]
  v_cvt_pk_bf16_f32 v42, v152, v153
  v_cvt_pk_bf16_f32 v43, v154, v155
  v_lshlrev_b32 v200, 16, v44
  v_and_b32 v201, s26, v44
  v_lshlrev_b32 v202, 16, v45
  v_and_b32 v203, s26, v45
  v_pk_mul_f32 v[168:169], v[168:169], v[200:201]
  v_pk_mul_f32 v[170:171], v[170:171], v[202:203]
  v_cvt_pk_bf16_f32 v44, v168, v169
  v_cvt_pk_bf16_f32 v45, v170, v171
  v_lshlrev_b32 v196, 16, v46
  v_and_b32 v197, s26, v46
  v_lshlrev_b32 v198, 16, v47
  v_and_b32 v199, s26, v47
  v_pk_mul_f32 v[184:185], v[184:185], v[196:197]
  v_pk_mul_f32 v[186:187], v[186:187], v[198:199]
  v_cvt_pk_bf16_f32 v46, v184, v185
  v_cvt_pk_bf16_f32 v47, v186, v187
  s_mov_b32 s24, 172032
  s_nop 1
  v_permlane16_swap_b32 v40, v42
  v_permlane16_swap_b32 v41, v43
  buffer_store_dwordx4 v[40:43], v192, s[12:15], s24 offen offset:0 sc1
  v_permlane16_swap_b32 v44, v46
  v_permlane16_swap_b32 v45, v47
  buffer_store_dwordx4 v[44:47], v192, s[12:15], s24 offen offset:64 sc1
  s_branch g2_end_63
g2_skip_61:
  s_cmp_lg_u32 s16, 0
  s_cbranch_scc1 pw_69
  s_add_u32 s64, s30, 71434240
  s_addc_u32 s65, s31, 0
  s_mov_b32 s66, 32768
  s_mov_b32 s67, 0x20000
  s_bfe_u32 s3, s2, 0x30004
  s_lshl_b32 s3, s3, 12
  v_and_b32 v250, 15, v0
  v_lshlrev_b32 v250, 8, v250
  v_add_u32 v250, s3, v250
  s_mov_b32 s3, 0x20000
  buffer_load_dword v251, v250, s[64:67], 0 offen sc1
pl_70:
  s_waitcnt vmcnt(0)
  v_cmp_gt_u32 vcc, 16, v251
  s_sub_u32 s3, s3, 1
  s_cbranch_scc1 pd_71
  s_cmp_eq_u64 vcc, 0
  s_cbranch_scc1 pd_71
  s_sleep 1
  buffer_load_dword v251, v250, s[64:67], 0 offen sc1
  s_branch pl_70
pd_71:
pw_69:
  s_barrier
g2_end_63:
  s_waitcnt vmcnt(0) lgkmcnt(0)
  s_barrier
  s_cmp_lg_u32 s16, 0
  s_cbranch_scc1 arr_72
  s_lshr_b32 s3, s2, 3
  s_cmp_ge_u32 s3, 28
  s_cbranch_scc1 arr_72
  s_add_u32 s64, s30, 71467008
  s_addc_u32 s65, s31, 0
  s_mov_b32 s66, 32768
  s_mov_b32 s67, 0x20000
  s_lshl_b32 s3, s40, 8
  v_mov_b32 v250, s3
  v_mov_b32 v251, 1
  s_mov_b64 exec, 1
  buffer_atomic_add v251, v250, s[64:67], 0 offen sc1
  s_mov_b64 exec, -1
arr_72:
  s_and_b32 s3, s2, 7
  s_lshr_b32 s29, s2, 3
  s_and_b32 s18, s3, 3
  s_lshl_b32 s18, s18, 2
  s_and_b32 s23, s29, 3
  s_add_u32 s18, s18, s23
  s_lshl_b32 s18, s18, 7
  s_lshr_b32 s17, s3, 2
  s_mul_i32 s17, s17, 8
  s_lshr_b32 s23, s29, 2
  s_xor_b32 s23, s23, 0
  s_add_u32 s17, s17, s23
  s_mul_i32 s17, s17, 64
  s_add_u32 s4, s30, 41943040
  s_addc_u32 s5, s31, 0
  s_mov_b32 s6, 3670016
  s_mov_b32 s7, 0x20000
  s_lshr_b32 s41, s17, 6
  s_mul_i32 s41, s41, 229376
  s_add_u32 s8, s30, 58720256
  s_addc_u32 s9, s31, 0
  s_mov_b32 s10, 7340032
  s_mov_b32 s11, 0x20000
  s_cmp_lt_u32 s16, 4
  s_cbranch_scc1 g3_cons_74
  s_sub_u32 s25, s16, 4
  s_lshl_b32 s23, s25, 6
  s_add_u32 s23, s23, 0
  v_add_u32 v7, s23, v0
  v_lshrrev_b32 v8, 3, v7
  v_and_b32 v7, 7, v7
  v_and_b32 v9, 2, v8
  v_xor_b32 v7, v7, v9
  v_lshrrev_b32 v9, 1, v8
  v_and_b32 v9, 4, v9
  v_xor_b32 v7, v7, v9
  v_lshlrev_b32 v7, 4, v7
  s_mov_b32 s24, 128
  v_mul_lo_u32 v8, v8, s24
  v_add_u32 v1, v7, v8
  s_lshl_b32 s23, s25, 6
  s_add_u32 s23, s23, 256
  v_add_u32 v7, s23, v0
  v_lshrrev_b32 v8, 3, v7
  v_and_b32 v7, 7, v7
  v_and_b32 v9, 2, v8
  v_xor_b32 v7, v7, v9
  v_lshrrev_b32 v9, 1, v8
  v_and_b32 v9, 4, v9
  v_xor_b32 v7, v7, v9
  v_lshlrev_b32 v7, 4, v7
  s_mov_b32 s24, 128
  v_mul_lo_u32 v8, v8, s24
  v_add_u32 v2, v7, v8
  s_and_b32 s23, s25, 1
  s_lshl_b32 s23, s23, 2
  v_lshrrev_b32 v7, 4, v0
  v_xor_b32 v7, s23, v7
  v_and_b32 v8, 7, v0
  v_xor_b32 v7, v7, v8
  v_lshlrev_b32 v7, 4, v7
  s_lshl_b32 s23, s25, 3
  s_add_u32 s23, s23, 0
  v_lshrrev_b32 v8, 3, v0
  v_add_u32 v8, s23, v8
  s_mov_b32 s24, 3584
  v_mul_lo_u32 v8, v8, s24
  v_add_u32 v3, v7, v8
  s_and_b32 s23, s25, 1
  s_lshl_b32 s23, s23, 2
  v_lshrrev_b32 v7, 4, v0
  v_xor_b32 v7, s23, v7
  v_and_b32 v8, 7, v0
  v_xor_b32 v7, v7, v8
  v_lshlrev_b32 v7, 4, v7
  s_lshl_b32 s23, s25, 3
  s_add_u32 s23, s23, 32
  v_lshrrev_b32 v8, 3, v0
  v_add_u32 v8, s23, v8
  s_mov_b32 s24, 3584
  v_mul_lo_u32 v8, v8, s24
  v_add_u32 v4, v7, v8
  s_and_b32 s23, s25, 1
  s_lshl_b32 s23, s23, 2
  v_lshrrev_b32 v7, 4, v0
  v_xor_b32 v7, s23, v7
  v_and_b32 v8, 7, v0
  v_xor_b32 v7, v7, v8
  v_lshlrev_b32 v7, 4, v7
  s_lshl_b32 s23, s25, 3
  s_add_u32 s23, s23, 64
  v_lshrrev_b32 v8, 3, v0
  v_add_u32 v8, s23, v8
  s_mov_b32 s24, 3584
  v_mul_lo_u32 v8, v8, s24
  v_add_u32 v5, v7, v8
  s_and_b32 s23, s25, 1
  s_lshl_b32 s23, s23, 2
  v_lshrrev_b32 v7, 4, v0
  v_xor_b32 v7, s23, v7
  v_and_b32 v8, 7, v0
  v_xor_b32 v7, v7, v8
  v_lshlrev_b32 v7, 4, v7
  s_lshl_b32 s23, s25, 3
  s_add_u32 s23, s23, 96
  v_lshrrev_b32 v8, 3, v0
  v_add_u32 v8, s23, v8
  s_mov_b32 s24, 3584
  v_mul_lo_u32 v8, v8, s24
  v_add_u32 v6, v7, v8
  s_mov_b32 s19, s41
  s_mul_i32 s20, s18, 3584
  s_lshl_b32 s21, s25, 10
  s_add_u32 s26, s21, 98304
  s_add_u32 m0, s21, 0
  s_nop 0
  buffer_load_dwordx4 v1, s[4:7], s19 offen sc1 lds
  s_add_u32 m0, s21, 4096
  s_nop 0
  buffer_load_dwordx4 v2, s[4:7], s19 offen sc1 lds
  s_add_u32 s19, s19, 8192
  s_add_u32 s21, s21, 24576
  s_cmp_ge_u32 s21, s26
  s_cselect_b32 s23, 98304, 0
  s_sub_u32 s21, s21, s23
  s_add_u32 m0, s21, 0
  s_nop 0
  buffer_load_dwordx4 v1, s[4:7], s19 offen sc1 lds
  s_add_u32 m0, s21, 4096
  s_nop 0
  buffer_load_dwordx4 v2, s[4:7], s19 offen sc1 lds
  s_add_u32 s19, s19, 8192
  s_add_u32 s21, s21, 24576
  s_cmp_ge_u32 s21, s26
  s_cselect_b32 s23, 98304, 0
  s_sub_u32 s21, s21, s23
  s_add_u32 m0, s21, 0
  s_nop 0
  buffer_load_dwordx4 v1, s[4:7], s19 offen sc1 lds
  s_add_u32 m0, s21, 4096
  s_nop 0
  buffer_load_dwordx4 v2, s[4:7], s19 offen sc1 lds
  s_add_u32 s19, s19, 8192
  s_add_u32 s21, s21, 24576
  s_cmp_ge_u32 s21, s26
  s_cselect_b32 s23, 98304, 0
  s_sub_u32 s21, s21, s23
  s_add_u32 m0, s21, 0
  s_nop 0
  buffer_load_dwordx4 v1, s[4:7], s19 offen sc1 lds
  s_add_u32 m0, s21, 4096
  s_nop 0
  buffer_load_dwordx4 v2, s[4:7], s19 offen sc1 lds
  s_add_u32 s19, s19, 8192
  s_add_u32 s21, s21, 24576
  s_cmp_ge_u32 s21, s26
  s_cselect_b32 s23, 98304, 0
  s_sub_u32 s21, s21, s23
  s_barrier
  s_add_u32 m0, s21, 8192
  s_nop 0
  buffer_load_dwordx4 v3, s[8:11], s20 offen sc1 lds
  s_add_u32 m0, s21, 12288
  s_nop 0
  buffer_load_dwordx4 v4, s[8:11], s20 offen sc1 lds
  s_add_u32 m0, s21, 16384
  s_nop 0
  buffer_load_dwordx4 v5, s[8:11], s20 offen sc1 lds
  s_add_u32 m0, s21, 20480
  s_nop 0
  buffer_load_dwordx4 v6, s[8:11], s20 offen sc1 lds
  s_add_u32 s20, s20, 128
  s_add_u32 s21, s21, 24576
  s_cmp_ge_u32 s21, s26
  s_cselect_b32 s23, 98304, 0
  s_sub_u32 s21, s21, s23
  s_add_u32 m0, s21, 8192
  s_nop 0
  buffer_load_dwordx4 v3, s[8:11], s20 offen sc1 lds
  s_add_u32 m0, s21, 12288
  s_nop 0
  buffer_load_dwordx4 v4, s[8:11], s20 offen sc1 lds
  s_add_u32 m0, s21, 16384
  s_nop 0
  buffer_load_dwordx4 v5, s[8:11], s20 offen sc1 lds
  s_add_u32 m0, s21, 20480
  s_nop 0
  buffer_load_dwordx4 v6, s[8:11], s20 offen sc1 lds
  s_add_u32 s20, s20, 128
  s_add_u32 s21, s21, 24576
  s_cmp_ge_u32 s21, s26
  s_cselect_b32 s23, 98304, 0
  s_sub_u32 s21, s21, s23
  s_add_u32 m0, s21, 8192
  s_nop 0
  buffer_load_dwordx4 v3, s[8:11], s20 offen sc1 lds
  s_add_u32 m0, s21, 12288
  s_nop 0
  buffer_load_dwordx4 v4, s[8:11], s20 offen sc1 lds
  s_add_u32 m0, s21, 16384
  s_nop 0
  buffer_load_dwordx4 v5, s[8:11], s20 offen sc1 lds
  s_add_u32 m0, s21, 20480
  s_nop 0
  buffer_load_dwordx4 v6, s[8:11], s20 offen sc1 lds
  s_add_u32 s20, s20, 128
  s_add_u32 s21, s21, 24576
  s_cmp_ge_u32 s21, s26
  s_cselect_b32 s23, 98304, 0
  s_sub_u32 s21, s21, s23
  s_add_u32 m0, s21, 8192
  s_nop 0
  buffer_load_dwordx4 v3, s[8:11], s20 offen sc1 lds
  s_add_u32 m0, s21, 12288
  s_nop 0
  buffer_load_dwordx4 v4, s[8:11], s20 offen sc1 lds
  s_add_u32 m0, s21, 16384
  s_nop 0
  buffer_load_dwordx4 v5, s[8:11], s20 offen sc1 lds
  s_add_u32 m0, s21, 20480
  s_nop 0
  buffer_load_dwordx4 v6, s[8:11], s20 offen sc1 lds
  s_add_u32 s20, s20, 128
  s_add_u32 s21, s21, 24576
  s_cmp_ge_u32 s21, s26
  s_cselect_b32 s23, 98304, 0
  s_sub_u32 s21, s21, s23
  s_waitcnt vmcnt(12)
  s_barrier
  s_waitcnt vmcnt(8)
  s_barrier
  s_add_u32 m0, s21, 0
  s_nop 0
  buffer_load_dwordx4 v1, s[4:7], s19 offen sc1 lds
  s_add_u32 m0, s21, 4096
  s_nop 0
  buffer_load_dwordx4 v2, s[4:7], s19 offen sc1 lds
  s_add_u32 m0, s21, 8192
  s_nop 0
  buffer_load_dwordx4 v3, s[8:11], s20 offen sc1 lds
  s_add_u32 m0, s21, 12288
  s_nop 0
  buffer_load_dwordx4 v4, s[8:11], s20 offen sc1 lds
  s_add_u32 m0, s21, 16384
  s_nop 0
  buffer_load_dwordx4 v5, s[8:11], s20 offen sc1 lds
  s_add_u32 m0, s21, 20480
  s_nop 0
  buffer_load_dwordx4 v6, s[8:11], s20 offen sc1 lds
  s_add_u32 s19, s19, 8192
  s_add_u32 s20, s20, 128
  s_add_u32 s21, s21, 24576
  s_cmp_ge_u32 s21, s26
  s_cselect_b32 s23, 98304, 0
  s_sub_u32 s21, s21, s23
  s_waitcnt vmcnt(10)
  s_barrier
  s_add_u32 m0, s21, 0
  s_nop 0
  buffer_load_dwordx4 v1, s[4:7], s19 offen sc1 lds
  s_add_u32 m0, s21, 4096
  s_nop 0
  buffer_load_dwordx4 v2, s[4:7], s19 offen sc1 lds
  s_add_u32 m0, s21, 8192
  s_nop 0
  buffer_load_dwordx4 v3, s[8:11], s20 offen sc1 lds
  s_add_u32 m0, s21, 12288
  s_nop 0
  buffer_load_dwordx4 v4, s[8:11], s20 offen sc1 lds
  s_add_u32 m0, s21, 16384
  s_nop 0
  buffer_load_dwordx4 v5, s[8:11], s20 offen sc1 lds
  s_add_u32 m0, s21, 20480
  s_nop 0
  buffer_load_dwordx4 v6, s[8:11], s20 offen sc1 lds
  s_add_u32 s19, s19, 8192
  s_add_u32 s20, s20, 128
  s_add_u32 s21, s21, 24576
  s_cmp_ge_u32 s21, s26
  s_cselect_b32 s23, 98304, 0
  s_sub_u32 s21, s21, s23
  s_waitcnt vmcnt(12)
  s_barrier
  s_add_u32 m0, s21, 0
  s_nop 0
  buffer_load_dwordx4 v1, s[4:7], s19 offen sc1 lds
  s_add_u32 m0, s21, 4096
  s_nop 0
  buffer_load_dwordx4 v2, s[4:7], s19 offen sc1 lds
  s_add_u32 m0, s21, 8192
  s_nop 0
  buffer_load_dwordx4 v3, s[8:11], s20 offen sc1 lds
  s_add_u32 m0, s21, 12288
  s_nop 0
  buffer_load_dwordx4 v4, s[8:11], s20 offen sc1 lds
  s_add_u32 m0, s21, 16384
  s_nop 0
  buffer_load_dwordx4 v5, s[8:11], s20 offen sc1 lds
  s_add_u32 m0, s21, 20480
  s_nop 0
  buffer_load_dwordx4 v6, s[8:11], s20 offen sc1 lds
  s_add_u32 s19, s19, 8192
  s_add_u32 s20, s20, 128
  s_add_u32 s21, s21, 24576
  s_cmp_ge_u32 s21, s26
  s_cselect_b32 s23, 98304, 0
  s_sub_u32 s21, s21, s23
  s_mov_b32 s22, 21
g3_pl_76:
  s_waitcnt vmcnt(12)
  s_barrier
  s_add_u32 m0, s21, 0
  s_nop 0
  buffer_load_dwordx4 v1, s[4:7], s19 offen sc1 lds
  s_add_u32 m0, s21, 4096
  s_nop 0
  buffer_load_dwordx4 v2, s[4:7], s19 offen sc1 lds
  s_add_u32 m0, s21, 8192
  s_nop 0
  buffer_load_dwordx4 v3, s[8:11], s20 offen sc1 lds
  s_add_u32 m0, s21, 12288
  s_nop 0
  buffer_load_dwordx4 v4, s[8:11], s20 offen sc1 lds
  s_add_u32 m0, s21, 16384
  s_nop 0
  buffer_load_dwordx4 v5, s[8:11], s20 offen sc1 lds
  s_add_u32 m0, s21, 20480
  s_nop 0
  buffer_load_dwordx4 v6, s[8:11], s20 offen sc1 lds
  s_add_u32 s19, s19, 8192
  s_add_u32 s20, s20, 128
  s_add_u32 s21, s21, 24576
  s_cmp_ge_u32 s21, s26
  s_cselect_b32 s23, 98304, 0
  s_sub_u32 s21, s21, s23
  s_sub_u32 s22, s22, 1
  s_cmp_lg_u32 s22, 0
  s_cbranch_scc1 g3_pl_76
  s_waitcnt vmcnt(12)
  s_barrier
  s_waitcnt vmcnt(6)
  s_barrier
  s_waitcnt vmcnt(0)
  s_barrier
  s_branch g3_end_75
g3_cons_74:
  s_and_b32 s27, s16, 1
  s_lshr_b32 s28, s16, 1
  v_lshrrev_b32 v11, 4, v0
  v_bfe_u32 v12, v0, 2, 2
  v_and_b32 v13, 1, v11
  v_lshlrev_b32 v13, 1, v13
  v_lshrrev_b32 v3, 1, v12
  v_or_b32 v13, v13, v3
  v_lshl_add_u32 v11, v11, 3, v12
  s_mov_b32 s24, 128
  v_mul_lo_u32 v11, v11, s24
  s_mul_i32 s23, s27, 2
  s_add_u32 s23, s23, 0
  v_xor_b32 v13, s23, v13
  v_lshlrev_b32 v13, 5, v13
  v_add_u32 v11, v11, v13
  v_and_b32 v12, 3, v0
  v_lshlrev_b32 v12, 3, v12
  v_add_u32 v11, v11, v12
  v_add_u32 v3, 0, v11
  v_lshrrev_b32 v11, 4, v0
  v_bfe_u32 v12, v0, 2, 2
  v_and_b32 v13, 1, v11
  v_lshlrev_b32 v13, 1, v13
  v_lshrrev_b32 v4, 1, v12
  v_or_b32 v13, v13, v4
  v_lshl_add_u32 v11, v11, 3, v12
  s_mov_b32 s24, 128
  v_mul_lo_u32 v11, v11, s24
  s_mul_i32 s23, s27, 2
  s_add_u32 s23, s23, 1
  v_xor_b32 v13, s23, v13
  v_lshlrev_b32 v13, 5, v13
  v_add_u32 v11, v11, v13
  v_and_b32 v12, 3, v0
  v_lshlrev_b32 v12, 3, v12
  v_add_u32 v11, v11, v12
  v_add_u32 v4, 0, v11
  v_and_b32 v11, 15, v0
  v_lshrrev_b32 v12, 1, v11
  v_lshrrev_b32 v13, 4, v0
  v_xor_b32 v12, v12, v13
  v_lshlrev_b32 v12, 4, v12
  v_lshlrev_b32 v11, 7, v11
  v_add_u32 v11, v11, v12
  s_mul_i32 s23, s28, 8192
  s_add_u32 s23, s23, 8192
  v_add_u32 v5, s23, v11
  v_and_b32 v11, 15, v0
  v_lshrrev_b32 v12, 1, v11
  v_lshrrev_b32 v13, 4, v0
  v_xor_b32 v12, v12, v13
  v_xor_b32 v12, 4, v12
  v_lshlrev_b32 v12, 4, v12
  v_lshlrev_b32 v11, 7, v11
  v_add_u32 v11, v11, v12
  s_mul_i32 s23, s28, 8192
  s_add_u32 s23, s23, 8192
  v_add_u32 v6, s23, v11
  s_mov_b32 s21, 0
  v_add_u32 v7, s21, v3
  v_add_u32 v8, s21, v4
  v_add_u32 v9, s21, v5
  v_add_u32 v10, s21, v6
  s_add_u32 s12, s30, 25165824
  s_addc_u32 s13, s31, 0
  s_mov_b32 s14, 4194304
  s_mov_b32 s15, 0x20000
  s_mul_i32 s23, s28, 64
  s_add_u32 s23, s23, s18
  v_and_b32 v108, 15, v0
  v_add_u32 v108, s23, v108
  s_mov_b32 s24, 2048
  v_mul_lo_u32 v108, v108, s24
  s_mul_i32 s23, s27, 32
  s_add_u32 s23, s23, s17
  s_lshl_b32 s23, s23, 1
  v_lshrrev_b32 v109, 4, v0
  v_lshlrev_b32 v109, 3, v109
  v_add3_u32 v108, v108, v109, s23
  s_mov_b32 s24, 0
  buffer_load_dwordx2 v[92:93], v108, s[12:15], s24 offen offset:0 sc1
  buffer_load_dwordx2 v[94:95], v108, s[12:15], s24 offen offset:32 sc1
  s_mov_b32 s24, 32768
  buffer_load_dwordx2 v[96:97], v108, s[12:15], s24 offen offset:0 sc1
  buffer_load_dwordx2 v[98:99], v108, s[12:15], s24 offen offset:32 sc1
  s_mov_b32 s24, 65536
  buffer_load_dwordx2 v[100:101], v108, s[12:15], s24 offen offset:0 sc1
  buffer_load_dwordx2 v[102:103], v108, s[12:15], s24 offen offset:32 sc1
  s_mov_b32 s24, 98304
  buffer_load_dwordx2 v[104:105], v108, s[12:15], s24 offen offset:0 sc1
  buffer_load_dwordx2 v[106:107], v108, s[12:15], s24 offen offset:32 sc1
  s_cmp_lg_u32 s16, 0
  s_cbranch_scc1 pw_77
  s_add_u32 s64, s30, 71467008
  s_addc_u32 s65, s31, 0
  s_mov_b32 s66, 32768
  s_mov_b32 s67, 0x20000
  s_lshr_b32 s3, s18, 7
  s_lshl_b32 s3, s3, 8
  v_mov_b32 v250, s3
  s_mov_b32 s3, 0x20000
  buffer_load_dword v251, v250, s[64:67], 0 offen sc1
pl_78:
  s_waitcnt vmcnt(0)
  v_cmp_gt_u32 vcc, 14, v251
  s_sub_u32 s3, s3, 1
  s_cbranch_scc1 pd_79
  s_cmp_eq_u64 vcc, 0
  s_cbranch_scc1 pd_79
  s_sleep 1
  buffer_load_dword v251, v250, s[64:67], 0 offen sc1
  s_branch pl_78
pd_79:
pw_77:
  s_barrier
  s_barrier
  ds_read_b128 v[20:23], v9 offset:0
  ds_read_b64_tr_b16 v[12:13], v7 offset:0
  ds_read_b64_tr_b16 v[14:15], v7 offset:512
  ds_read_b128 v[24:27], v9 offset:2048
  ds_read_b128 v[28:31], v9 offset:4096
  ds_read_b128 v[32:35], v9 offset:6144
  ds_read_b64_tr_b16 v[16:17], v8 offset:0
  ds_read_b64_tr_b16 v[18:19], v8 offset:512
  s_mov_b32 s26, 0xffff0000
  s_waitcnt vmcnt(0)
  v_lshlrev_b32 v60, 16, v92
  v_and_b32 v61, s26, v92
  v_lshlrev_b32 v62, 16, v93
  v_and_b32 v63, s26, v93
  v_lshlrev_b32 v76, 16, v94
  v_and_b32 v77, s26, v94
  v_lshlrev_b32 v78, 16, v95
  v_and_b32 v79, s26, v95
  v_lshlrev_b32 v64, 16, v96
  v_and_b32 v65, s26, v96
  v_lshlrev_b32 v66, 16, v97
  v_and_b32 v67, s26, v97
  v_lshlrev_b32 v80, 16, v98
  v_and_b32 v81, s26, v98
  v_lshlrev_b32 v82, 16, v99
  v_and_b32 v83, s26, v99
  v_lshlrev_b32 v68, 16, v100
  v_and_b32 v69, s26, v100
  v_lshlrev_b32 v70, 16, v101
  v_and_b32 v71, s26, v101
  v_lshlrev_b32 v84, 16, v102
  v_and_b32 v85, s26, v102
  v_lshlrev_b32 v86, 16, v103
  v_and_b32 v87, s26, v103
  v_lshlrev_b32 v72, 16, v104
  v_and_b32 v73, s26, v104
  v_lshlrev_b32 v74, 16, v105
  v_and_b32 v75, s26, v105
  v_lshlrev_b32 v88, 16, v106
  v_and_b32 v89, s26, v106
  v_lshlrev_b32 v90, 16, v107
  v_and_b32 v91, s26, v107
  s_nop 1
  s_waitcnt lgkmcnt(0)
  s_mov_b32 s22, 27
g3_cl_80:
  v_mfma_f32_16x16x32_bf16 v[60:63], v[12:15], v[20:23], v[60:63]
  ds_read_b128 v[44:47], v10 offset:0
  ds_read_b64_tr_b16 v[36:37], v7 offset:4096
  v_mfma_f32_16x16x32_bf16 v[64:67], v[12:15], v[24:27], v[64:67]
  ds_read_b64_tr_b16 v[38:39], v7 offset:4608
  ds_read_b128 v[48:51], v10 offset:2048
  v_mfma_f32_16x16x32_bf16 v[68:71], v[12:15], v[28:31], v[68:71]
  ds_read_b128 v[52:55], v10 offset:4096
  ds_read_b128 v[56:59], v10 offset:6144
  v_mfma_f32_16x16x32_bf16 v[72:75], v[12:15], v[32:35], v[72:75]
  ds_read_b64_tr_b16 v[40:41], v8 offset:4096
  ds_read_b64_tr_b16 v[42:43], v8 offset:4608
  v_mfma_f32_16x16x32_bf16 v[76:79], v[16:19], v[20:23], v[76:79]
  s_add_u32 s21, s21, 24576
  s_cmp_ge_u32 s21, 98304
  v_mfma_f32_16x16x32_bf16 v[80:83], v[16:19], v[24:27], v[80:83]
  s_cselect_b32 s23, 98304, 0
  s_sub_u32 s21, s21, s23
  v_mfma_f32_16x16x32_bf16 v[84:87], v[16:19], v[28:31], v[84:87]
  v_add_u32 v7, s21, v3
  v_add_u32 v8, s21, v4
  v_mfma_f32_16x16x32_bf16 v[88:91], v[16:19], v[32:35], v[88:91]
  v_add_u32 v9, s21, v5
  v_add_u32 v10, s21, v6
  s_waitcnt lgkmcnt(0)
  s_barrier
  v_mfma_f32_16x16x32_bf16 v[60:63], v[36:39], v[44:47], v[60:63]
  ds_read_b128 v[20:23], v9 offset:0
  ds_read_b64_tr_b16 v[12:13], v7 offset:0
  v_mfma_f32_16x16x32_bf16 v[64:67], v[36:39], v[48:51], v[64:67]
  ds_read_b64_tr_b16 v[14:15], v7 offset:512
  ds_read_b128 v[24:27], v9 offset:2048
  v_mfma_f32_16x16x32_bf16 v[68:71], v[36:39], v[52:55], v[68:71]
  ds_read_b128 v[28:31], v9 offset:4096
  ds_read_b128 v[32:35], v9 offset:6144
  v_mfma_f32_16x16x32_bf16 v[72:75], v[36:39], v[56:59], v[72:75]
  ds_read_b64_tr_b16 v[16:17], v8 offset:0
  ds_read_b64_tr_b16 v[18:19], v8 offset:512
  v_mfma_f32_16x16x32_bf16 v[76:79], v[40:43], v[44:47], v[76:79]
  s_sub_u32 s22, s22, 1
  v_mfma_f32_16x16x32_bf16 v[80:83], v[40:43], v[48:51], v[80:83]
  v_mfma_f32_16x16x32_bf16 v[84:87], v[40:43], v[52:55], v[84:87]
  v_mfma_f32_16x16x32_bf16 v[88:91], v[40:43], v[56:59], v[88:91]
  s_waitcnt lgkmcnt(0)
  s_cmp_lg_u32 s22, 0
  s_cbranch_scc1 g3_cl_80
  v_mfma_f32_16x16x32_bf16 v[60:63], v[12:15], v[20:23], v[60:63]
  ds_read_b128 v[44:47], v10 offset:0
  ds_read_b64_tr_b16 v[36:37], v7 offset:4096
  v_mfma_f32_16x16x32_bf16 v[64:67], v[12:15], v[24:27], v[64:67]
  ds_read_b64_tr_b16 v[38:39], v7 offset:4608
  ds_read_b128 v[48:51], v10 offset:2048
  v_mfma_f32_16x16x32_bf16 v[68:71], v[12:15], v[28:31], v[68:71]
  ds_read_b128 v[52:55], v10 offset:4096
  ds_read_b128 v[56:59], v10 offset:6144
  v_mfma_f32_16x16x32_bf16 v[72:75], v[12:15], v[32:35], v[72:75]
  ds_read_b64_tr_b16 v[40:41], v8 offset:4096
  ds_read_b64_tr_b16 v[42:43], v8 offset:4608
  v_mfma_f32_16x16x32_bf16 v[76:79], v[16:19], v[20:23], v[76:79]
  v_mfma_f32_16x16x32_bf16 v[80:83], v[16:19], v[24:27], v[80:83]
  v_mfma_f32_16x16x32_bf16 v[84:87], v[16:19], v[28:31], v[84:87]
  v_mfma_f32_16x16x32_bf16 v[88:91], v[16:19], v[32:35], v[88:91]
  s_waitcnt lgkmcnt(0)
  v_mfma_f32_16x16x32_bf16 v[60:63], v[36:39], v[44:47], v[60:63]
  v_mfma_f32_16x16x32_bf16 v[64:67], v[36:39], v[48:51], v[64:67]
  v_mfma_f32_16x16x32_bf16 v[68:71], v[36:39], v[52:55], v[68:71]
  v_mfma_f32_16x16x32_bf16 v[72:75], v[36:39], v[56:59], v[72:75]
  v_mfma_f32_16x16x32_bf16 v[76:79], v[40:43], v[44:47], v[76:79]
  v_mfma_f32_16x16x32_bf16 v[80:83], v[40:43], v[48:51], v[80:83]
  v_mfma_f32_16x16x32_bf16 v[84:87], v[40:43], v[52:55], v[84:87]
  v_mfma_f32_16x16x32_bf16 v[88:91], v[40:43], v[56:59], v[88:91]
  s_mov_b32 s12, s96
  s_mov_b32 s13, s97
  s_mov_b32 s14, 4194304
  s_mov_b32 s15, 0x20000
  s_nop 3
  v_lshrrev_b32 v110, 4, v0
  v_lshlrev_b32 v111, 3, v110
  v_sub_u32 v108, v108, v111
  v_and_b32 v111, 1, v110
  v_lshlrev_b32 v111, 5, v111
  v_lshrrev_b32 v110, 1, v110
  v_lshlrev_b32 v110, 4, v110
  v_add3_u32 v108, v108, v110, v111
  v_cvt_pk_bf16_f32 v92, v60, v61
  v_cvt_pk_bf16_f32 v93, v62, v63
  v_cvt_pk_bf16_f32 v94, v76, v77
  v_cvt_pk_bf16_f32 v95, v78, v79
  s_mov_b32 s24, 0
  s_nop 1
  v_permlane16_swap_b32 v92, v94
  v_permlane16_swap_b32 v93, v95
  buffer_store_dwordx4 v[92:95], v108, s[12:15], s24 offen offset:0
  v_cvt_pk_bf16_f32 v96, v64, v65
  v_cvt_pk_bf16_f32 v97, v66, v67
  v_cvt_pk_bf16_f32 v98, v80, v81
  v_cvt_pk_bf16_f32 v99, v82, v83
  s_mov_b32 s24, 32768
  s_nop 1
  v_permlane16_swap_b32 v96, v98
  v_permlane16_swap_b32 v97, v99
  buffer_store_dwordx4 v[96:99], v108, s[12:15], s24 offen offset:0
  v_cvt_pk_bf16_f32 v100, v68, v69
  v_cvt_pk_bf16_f32 v101, v70, v71
  v_cvt_pk_bf16_f32 v102, v84, v85
  v_cvt_pk_bf16_f32 v103, v86, v87
  s_mov_b32 s24, 65536
  s_nop 1
  v_permlane16_swap_b32 v100, v102
  v_permlane16_swap_b32 v101, v103
  buffer_store_dwordx4 v[100:103], v108, s[12:15], s24 offen offset:0
  v_cvt_pk_bf16_f32 v104, v72, v73
  v_cvt_pk_bf16_f32 v105, v74, v75
  v_cvt_pk_bf16_f32 v106, v88, v89
  v_cvt_pk_bf16_f32 v107, v90, v91
  s_mov_b32 s24, 98304
  s_nop 1
  v_permlane16_swap_b32 v104, v106
  v_permlane16_swap_b32 v105, v107
  buffer_store_dwordx4 v[104:107], v108, s[12:15], s24 offen offset:0
  s_branch g3_end_75
g3_skip_73:
g3_end_75:
L_done:
  s_endpgm
.section .rodata,"a"
.p2align 6
.amdhsa_kernel sequential_preLN__spectral_gfnet__mixer_gmlp__prompt_kernel
  .amdhsa_next_free_vgpr 256
  .amdhsa_next_free_sgpr 102
  .amdhsa_accum_offset 256
  .amdhsa_group_segment_fixed_size 0
  .amdhsa_kernarg_size 88
  .amdhsa_user_sgpr_count 2
  .amdhsa_user_sgpr_kernarg_segment_ptr 1
  .amdhsa_system_sgpr_workgroup_id_x 1
  .amdhsa_float_denorm_mode_32 3
.end_amdhsa_kernel
```
